```python
import torch

def _softmax(x, axis=-1):
    return torch.softmax(x, dim=axis)
def _gelu(x):
    return torch.nn.functional.gelu(x, approximate="tanh")
def _silu(x):
    return torch.nn.functional.silu(x)
def _sigmoid(x):
    return torch.sigmoid(x)
def _layernorm(x, axis=-1, eps=1e-5):
    m = x.mean(dim=axis, keepdim=True)
    v = x.var(dim=axis, keepdim=True, unbiased=False)
    return (x - m) / torch.sqrt(v + eps)
def _scatter_add(tgt, idx, src, axis=0):
    return tgt.clone().index_add_(axis, idx, src)
def _segment_sum(src, seg, n):
    out = torch.zeros((n,) + src.shape[1:], dtype=src.dtype)
    return out.index_add_(0, seg, src)
def _pad(x, pw):
    flat = tuple(v for pair in reversed(pw) for v in pair)
    return torch.nn.functional.pad(x, flat)

kernel_name = 'gated_mix__gqa_block_cached__glu_gated_reglu__decode'

def setup_inputs():

    _w = (lambda a: (lambda t: t.to(torch.bfloat16) if t.is_floating_point() else t)(torch.as_tensor(a)))
    def _A_setup():
        B, Sq, D = 1, 1, 1024
        Hq, Hkv, Sk, Dh = 32, 4, 65536, 128
        assert Hq % Hkv == 0, (Hq, Hkv)
        return {
            "x": _w((lambda *s: torch.randn(*s, dtype=torch.bfloat16) * 0.05)(B, Sq, D)),
            "k_cache": _w((lambda *s: torch.randn(*s, dtype=torch.bfloat16) * 3.2)(B, Hkv, Sk, Dh)),
            "v_cache": _w((lambda *s: torch.randn(*s, dtype=torch.bfloat16) * 1.6)(B, Hkv, Sk, Dh)),
            "wq": _w((lambda *s: torch.randn(*s, dtype=torch.bfloat16) * 3.2)(D, Hq * Dh) * (D ** -0.5)),
            "wo": _w((lambda *s: torch.randn(*s, dtype=torch.bfloat16) * 1.6)(Hq * Dh, D) * ((Hq * Dh) ** -0.5)),
        }
    _A_in = _A_setup()

    def _B_setup():
        B, S, D, F = 1, 1, 1024, 3584
        return {
            "x": _w((lambda *s: torch.randn(*s, dtype=torch.bfloat16) * 0.05)(B, S, D)),
            "W_gate": _w((lambda *s: torch.randn(*s, dtype=torch.bfloat16) * 1.6)(D, F) * (2.0 / D) ** 0.5),
            "W_up": _w((lambda *s: torch.randn(*s, dtype=torch.bfloat16) * 1.6)(D, F) * (2.0 / D) ** 0.5),
            "W_down": _w((lambda *s: torch.randn(*s, dtype=torch.bfloat16) * 1.6)(F, D) * (1.0 / F) ** 0.5),
        }
    _B_in = _B_setup()

    return {
        "A_x": _A_in["x"],
        "A_k_cache": _A_in["k_cache"],
        "A_v_cache": _A_in["v_cache"],
        "A_wq": _A_in["wq"],
        "A_wo": _A_in["wo"],
        "B_x": _B_in["x"],
        "B_W_gate": _B_in["W_gate"],
        "B_W_up": _B_in["W_up"],
        "B_W_down": _B_in["W_down"],
        "gate_w": _w((lambda *s: torch.randn(*s, dtype=torch.bfloat16) * 0.05)(1024) * 16.0),
    }

def reference(A_x, A_k_cache, A_v_cache, A_wq, A_wo, B_x, B_W_gate, B_W_up, B_W_down, gate_w):
    def _A_ref(x, k_cache, v_cache, wq, wo):
        B, Sq, D = x.shape
        Hq, Dh = 32, 128
        Hkv = k_cache.shape[1]
        rep = Hq // Hkv
        q = (lambda x, *d: x.permute(*d))((x @ wq).reshape(B, Sq, Hq, Dh), 0, 2, 1, 3)
        k = (lambda x, n, axis: torch.repeat_interleave(x, n, dim=axis))(k_cache, rep, axis=1)
        v = (lambda x, n, axis: torch.repeat_interleave(x, n, dim=axis))(v_cache, rep, axis=1)
        scores = torch.einsum("bhqd,bhkd->bhqk", q, k) * (Dh ** -0.5)
        p = _softmax(scores, axis=-1)
        o = torch.einsum("bhqk,bhkd->bhqd", p, v)
        return (lambda x, *d: x.permute(*d))(o, 0, 2, 1, 3).reshape(B, Sq, Hq * Dh) @ wo

    def _B_ref(x, W_gate, W_up, W_down):
        gate = torch.einsum("bsd,df->bsf", x, W_gate)
        up = torch.einsum("bsd,df->bsf", x, W_up)
        gate = gate * (lambda x, dt: x.to(dt))(gate > 0, gate.dtype)
        h = gate * up
        return torch.einsum("bsf,fd->bsd", h, W_down)

    x = A_x
    g = _sigmoid((x * gate_w).sum(-1, keepdims=True))
    a = _A_ref(x, A_k_cache, A_v_cache, A_wq, A_wo)
    b = _B_ref(x, B_W_gate, B_W_up, B_W_down)
    return g * a + (1 - g) * b
```

```asm
; @launch grid=(256,1,1) block=(768,1,1) lds=153856
.amdgcn_target "amdgcn-amd-amdhsa--gfx950"
.text
.globl gated_mix__gqa_block_cached__glu_gated_reglu__decode_kernel
.p2align 8
.type gated_mix__gqa_block_cached__glu_gated_reglu__decode_kernel,@function
gated_mix__gqa_block_cached__glu_gated_reglu__decode_kernel:
    s_cmp_ge_u32 s2, 256
    s_cbranch_scc1 L_end
    s_load_dwordx2 s[8:9], s[0:1], 24
    s_load_dwordx2 s[16:17], s[0:1], 96
    s_load_dwordx2 s[12:13], s[0:1], 0
    s_load_dwordx4 s[40:43], s[0:1], 64
    s_load_dwordx2 s[44:45], s[0:1], 80
    s_load_dwordx4 s[36:39], s[0:1], 48
    s_load_dwordx4 s[64:67], s[0:1], 8
    s_load_dwordx2 s[46:47], s[0:1], 32
    v_lshrrev_b32 v1, 6, v0
    v_and_b32 v0, 63, v0
    v_mov_b32 v6, 131072
    v_readfirstlane_b32 s3, v1
    v_mov_b32 v8, 0
    v_mov_b32 v9, 0
    v_lshl_add_u32 v1, v0, 3, v6
    ds_write_b64 v1, v[8:9]
    s_mov_b32 s11, 0x20000
    s_lshr_b32 s54, s2, 2
    s_and_b32 s55, s2, 3
    s_cmp_lg_u32 s3, 0
    s_cbranch_scc0 L_loader
    s_waitcnt lgkmcnt(0)
    s_barrier
    s_branch L_others
L_loader:
    s_setprio 3
    s_mov_b32 s10, 0x800000
    v_and_b32 v2, 7, v0
    v_lshlrev_b32 v2, 4, v2
    v_lshrrev_b32 v3, 3, v0
    v_lshl_add_u32 v8, v3, 16, v2
    v_add_u32 v9, 7168, v8
    v_add_u32 v10, 14336, v8
    v_add_u32 v11, 21504, v8
    v_add_u32 v12, 32768, v8
    v_add_u32 v13, 39936, v8
    v_add_u32 v14, 47104, v8
    v_add_u32 v15, 54272, v8
    s_lshl_b32 s22, s55, 21
    s_lshl_b32 s58, s54, 7
    s_add_u32 s22, s22, s58
    s_mov_b32 s20, 0
    s_mov_b32 s23, 524288
    s_mov_b32 m0, 0
    s_waitcnt lgkmcnt(0)
L_first:
    buffer_load_dwordx4 v8, s[8:11], s22 offen offset:0 nt lds
    buffer_load_dwordx4 v9, s[8:11], s22 offen offset:1024 nt lds
    buffer_load_dwordx4 v10, s[8:11], s22 offen offset:2048 nt lds
    buffer_load_dwordx4 v11, s[8:11], s22 offen offset:3072 nt lds
    s_add_u32 m0, m0, 4096
    s_add_u32 s20, s20, 1
    buffer_load_dwordx4 v12, s[8:11], s22 offen offset:0 nt lds
    buffer_load_dwordx4 v13, s[8:11], s22 offen offset:1024 nt lds
    buffer_load_dwordx4 v14, s[8:11], s22 offen offset:2048 nt lds
    buffer_load_dwordx4 v15, s[8:11], s22 offen offset:3072 nt lds
    s_add_u32 m0, m0, 4096
    s_add_u32 s22, s22, s23
    s_cmp_lt_u32 s20, 4
    s_cbranch_scc1 L_first
    s_barrier
    s_mov_b32 s21, 32768
    v_mov_b32 v16, 131152
    v_lshlrev_b32 v5, 2, v0
    v_add_u32 v5, 131328, v5
    v_mov_b32 v4, 2
    s_mov_b32 s18, 0x10000000
    s_mov_b32 s19, 0x20000
    v_mov_b32 v18, 0
L_phases:
    s_mov_b32 s68, 0
    v_and_b32 v2, 7, v0
    v_lshlrev_b32 v2, 4, v2
    v_lshrrev_b32 v3, 3, v0
    v_mul_u32_u24 v8, 57344, v3
    v_add_u32 v8, v8, v2
    v_add_u32 v9, 6144, v8
    v_add_u32 v10, 12288, v8
    v_add_u32 v11, 18432, v8
    v_add_u32 v12, 28672, v8
    v_add_u32 v13, 34816, v8
    v_add_u32 v14, 40960, v8
    v_add_u32 v15, 47104, v8
    s_mov_b32 s8, s36
    s_mov_b32 s9, s37
    s_mov_b32 s53, s54
    s_cmp_lt_u32 s2, 224
    s_cselect_b32 s10, 0x700000, 0
    s_mul_i32 s26, s55, 1835008
    s_add_u32 s22, s53, 1
    s_cmp_ge_u32 s22, 56
    s_cselect_b32 s29, 56, 0
    s_sub_u32 s22, s22, s29
    s_lshl_b32 s22, s22, 7
    s_add_u32 s22, s22, s26
    s_add_u32 s28, s53, 2
    s_cmp_ge_u32 s28, 56
    s_cselect_b32 s29, 56, 0
    s_sub_u32 s28, s28, s29
    s_lshl_b32 s28, s28, 7
    s_add_u32 s26, s26, s28
    s_mov_b32 s23, 458752
    s_mov_b32 s24, s23
    s_mov_b32 s27, 4
    s_mov_b32 s25, 8
    s_call_b64 s[30:31], L_tiles
    s_mov_b32 s8, s38
    s_mov_b32 s9, s39
    s_mov_b32 s22, s26
    s_mov_b32 s25, 12
    s_call_b64 s[30:31], L_tiles
    v_lshrrev_b32 v3, 4, v0
    v_and_b32 v2, 15, v0
    v_xor_b32 v1, v2, v3
    v_xor_b32 v7, 0, v1
    v_lshlrev_b32 v7, 4, v7
    v_lshl_add_u32 v8, v3, 8, v7
    v_add_u32 v12, 4096, v8
    v_xor_b32 v7, 4, v1
    v_lshlrev_b32 v7, 4, v7
    v_lshl_add_u32 v9, v3, 8, v7
    v_add_u32 v13, 4096, v9
    v_xor_b32 v7, 8, v1
    v_lshlrev_b32 v7, 4, v7
    v_lshl_add_u32 v10, v3, 8, v7
    v_add_u32 v14, 4096, v10
    v_xor_b32 v7, 12, v1
    v_lshlrev_b32 v7, 4, v7
    v_lshl_add_u32 v11, v3, 8, v7
    v_add_u32 v15, 4096, v11
    s_mov_b32 s8, s64
    s_mov_b32 s9, s65
    s_mov_b32 s10, 0x4000000
    s_and_b32 s26, s2, 63
    s_lshl_b32 s26, s26, 16
    s_lshr_b32 s29, s2, 6
    s_lshl_b32 s29, s29, 24
    s_add_u32 s26, s26, s29
    s_mov_b32 s22, s26
    s_movk_i32 s23, 8192
    s_mov_b32 s24, 4136960
    s_mov_b32 s25, 44
    s_call_b64 s[30:31], L_tiles
    v_lshlrev_b32 v1, 1, v3
    v_xor_b32 v1, v2, v1
    v_lshlrev_b32 v1, 4, v1
    v_lshl_add_u32 v8, v3, 8, v1
    v_xor_b32 v9, 128, v8
    v_mov_b32 v10, v8
    v_mov_b32 v11, v9
    v_add_u32 v12, 4096, v8
    v_add_u32 v13, 4096, v9
    v_mov_b32 v14, v12
    v_mov_b32 v15, v13
    s_mov_b32 s8, s66
    s_mov_b32 s9, s67
    s_mov_b32 s10, 0x4000000
    s_mov_b32 s22, s26
    s_mov_b32 s25, 76
    s_call_b64 s[30:31], L_tiles
    s_mov_b32 s26, s22
    s_mov_b32 s68, 1
    v_subrev_u32 v4, 3, v4
    v_mul_u32_u24 v8, 14336, v3
    v_lshl_add_u32 v8, v2, 4, v8
    v_add_u32 v9, 1024, v8
    v_add_u32 v10, 2048, v8
    v_add_u32 v11, 3072, v8
    v_add_u32 v12, 8192, v8
    v_add_u32 v13, 9216, v8
    v_add_u32 v14, 10240, v8
    v_mov_b32 v15, 0x7f000000
    s_cmp_lt_u32 s20, 1000
    s_cselect_b32 s29, 1, 0
    s_mov_b32 s62, 1048576
L_ld_fh:
    ds_read_b32 v7, v6 offset:24
    s_waitcnt lgkmcnt(0)
    v_readfirstlane_b32 s61, v7
    s_cmp_ge_i32 s61, s29
    s_cbranch_scc1 L_ld_fh_done
    s_sub_u32 s62, s62, 1
    s_cmp_lg_u32 s62, 0
    s_cbranch_scc1 L_ld_fh
L_ld_fh_done:
    v_lshl_add_u32 v1, v3, 4, v6
    ds_read_b128 v[20:23], v1 offset:192
    s_waitcnt lgkmcnt(0)
    v_and_b32 v1, 0x7fff, v20
    v_cmp_eq_u32 vcc, 0, v1
    s_nop 1
    v_cndmask_b32 v8, v8, v15, vcc
    v_and_b32 v1, 0x7fff0000, v20
    v_cmp_eq_u32 vcc, 0, v1
    s_nop 1
    v_cndmask_b32 v9, v9, v15, vcc
    v_and_b32 v1, 0x7fff, v21
    v_cmp_eq_u32 vcc, 0, v1
    s_nop 1
    v_cndmask_b32 v10, v10, v15, vcc
    v_and_b32 v1, 0x7fff0000, v21
    v_cmp_eq_u32 vcc, 0, v1
    s_nop 1
    v_cndmask_b32 v11, v11, v15, vcc
    v_and_b32 v1, 0x7fff, v22
    v_cmp_eq_u32 vcc, 0, v1
    s_nop 1
    v_cndmask_b32 v12, v12, v15, vcc
    v_and_b32 v1, 0x7fff0000, v22
    v_cmp_eq_u32 vcc, 0, v1
    s_nop 1
    v_cndmask_b32 v13, v13, v15, vcc
    v_and_b32 v1, 0x7fff, v23
    v_cmp_eq_u32 vcc, 0, v1
    s_nop 1
    v_cndmask_b32 v14, v14, v15, vcc
    s_mov_b32 s8, s40
    s_mov_b32 s9, s41
    s_mov_b32 s10, 0x700000
    s_lshr_b32 s56, s2, 1
    s_and_b32 s57, s2, 1
    s_lshl_b32 s57, s57, 10
    s_mul_i32 s22, s56, 57344
    s_add_u32 s22, s22, s57
    s_movk_i32 s23, 256
    s_movk_i32 s24, 256
    s_mov_b32 s25, 80
    s_call_b64 s[30:31], L_tiles
    v_lshrrev_b32 v1, 1, v3
    v_lshlrev_b32 v1, 18, v1
    v_and_b32 v7, 1, v3
    v_lshl_add_u32 v1, v7, 14, v1
    v_lshl_add_u32 v8, v2, 4, v1
    v_add_u32 v9, 1024, v8
    v_add_u32 v10, 2048, v8
    v_add_u32 v11, 3072, v8
    v_add_u32 v12, 8192, v8
    v_add_u32 v13, 9216, v8
    v_add_u32 v14, 10240, v8
    v_add_u32 v15, 11264, v8
    s_mov_b32 s8, s46
    s_mov_b32 s9, s47
    s_mov_b32 s10, 0x800000
    s_lshr_b32 s22, s2, 6
    s_lshl_b32 s22, s22, 21
    s_and_b32 s29, s56, 3
    s_lshl_b32 s29, s29, 19
    s_add_u32 s22, s22, s29
    s_and_b32 s29, s56, 28
    s_lshl_b32 s29, s29, 13
    s_add_u32 s22, s22, s29
    s_add_u32 s22, s22, s57
    s_movk_i32 s23, 256
    s_movk_i32 s24, 256
    s_mov_b32 s25, 84
    s_call_b64 s[30:31], L_tiles
    s_cmp_lt_u32 s20, 1000
    s_cbranch_scc0 L_a3_cont
    v_mov_b32 v4, 160
    s_waitcnt vmcnt(32)
    ds_max_i32 v5, v4
    v_mov_b32 v4, 162
    s_waitcnt vmcnt(24)
    ds_max_i32 v5, v4
    v_mov_b32 v4, 164
    s_waitcnt vmcnt(16)
    ds_max_i32 v5, v4
    v_mov_b32 v4, 166
    s_waitcnt vmcnt(8)
    ds_max_i32 v5, v4
    v_mov_b32 v4, 168
    s_waitcnt vmcnt(0)
    ds_max_i32 v5, v4
    s_endpgm
L_tiles:
    s_cmp_lt_u32 s20, s25
    s_cbranch_scc0 L_tiles_ret
L_tiles_top:
    s_lshr_b32 s28, s20, 4
    s_lshl_b32 s28, s28, 3
    s_mov_b32 m0, s21
    s_waitcnt lgkmcnt(0)
    v_readfirstlane_b32 s29, v18
    s_cmp_ge_u32 s29, s28
    s_cbranch_scc0 L_tiles_slow
L_tiles_go:
    s_cmp_lg_u32 s68, 0
    s_cbranch_scc1 L_tiles_wa
    s_waitcnt vmcnt(24)
L_tiles_wa:
    s_waitcnt vmcnt(36)
    ds_max_i32 v5, v4
    buffer_load_dwordx4 v8, s[8:11], s22 offen offset:0 nt lds
    buffer_load_dwordx4 v9, s[8:11], s22 offen offset:1024 nt lds
    buffer_load_dwordx4 v10, s[8:11], s22 offen offset:2048 nt lds
    buffer_load_dwordx4 v11, s[8:11], s22 offen offset:3072 nt lds
    s_add_u32 m0, s21, 4096
    v_add_u32 v4, 1, v4
    s_add_u32 s20, s20, 1
    s_add_u32 s21, s21, 8192
    s_and_b32 s21, s21, 0x1ffff
    s_lshr_b32 s29, s21, 11
    s_add_u32 s29, s29, 131136
    v_mov_b32 v16, s29
    s_add_u32 s29, s20, s27
    s_and_b32 s29, s29, 7
    s_cselect_b32 s29, s23, s24
    s_cmp_lg_u32 s68, 0
    s_cbranch_scc1 L_tiles_wb
    s_waitcnt vmcnt(24)
L_tiles_wb:
    s_waitcnt vmcnt(36)
    ds_max_i32 v5, v4
    buffer_load_dwordx4 v12, s[8:11], s22 offen offset:0 nt lds
    buffer_load_dwordx4 v13, s[8:11], s22 offen offset:1024 nt lds
    buffer_load_dwordx4 v14, s[8:11], s22 offen offset:2048 nt lds
    buffer_load_dwordx4 v15, s[8:11], s22 offen offset:3072 nt lds
    ds_read_b32 v18, v16
    v_add_u32 v4, 1, v4
    s_add_u32 s22, s22, s29
    s_cmp_lt_u32 s20, s25
    s_cbranch_scc1 L_tiles_top
L_tiles_ret:
    s_setpc_b64 s[30:31]
L_tiles_slow:
    s_mov_b32 s62, 1048576
L_tiles_spin:
    ds_read_b32 v18, v16
    s_waitcnt lgkmcnt(0)
    v_readfirstlane_b32 s29, v18
    s_cmp_ge_u32 s29, s28
    s_cbranch_scc1 L_tiles_go
    s_sub_u32 s62, s62, 1
    s_cmp_lg_u32 s62, 0
    s_cbranch_scc1 L_tiles_spin
    s_branch L_tiles_go
L_others:
    s_load_dword s6, s[16:17], 0
    s_movk_i32 s14, 2048
    s_mov_b32 s15, 0x20000
    s_mov_b32 s18, 0x10000000
    s_mov_b32 s19, 0x20000
    s_cmp_eq_u32 s3, 3
    s_cbranch_scc1 L_a3
    s_mov_b32 s4, 0x05040100
    s_mov_b32 s5, 0x07060302
    s_lshr_b32 s52, s2, 6
    s_lshr_b32 s56, s2, 1
    s_waitcnt lgkmcnt(0)
    s_add_u32 s6, s6, 0x9e3779b9
    s_not_b32 s7, s6
    s_bfe_u32 s32, s6, 524288
    s_bfe_u32 s33, s6, 524296
    s_bfe_u32 s34, s6, 524304
    s_bfe_u32 s35, s6, 524312
    s_cmp_lt_u32 s3, 4
    s_cbranch_scc1 L_aux
    s_sub_u32 s50, s3, 4
    v_lshrrev_b32 v5, 4, v0
    v_and_b32 v1, 1, v0
    v_lshl_add_u32 v1, v5, 1, v1
    v_lshlrev_b32 v1, 4, v1
    s_and_b32 s51, s50, 3
    s_lshl_b32 s57, s55, 2
    s_add_u32 s57, s57, s51
    s_lshl_b32 s57, s57, 7
    buffer_load_dwordx4 v[16:19], v1, s[12:15], s57 offen
    v_lshlrev_b32 v4, 4, v0
    v_and_b32 v3, 7, v0
    v_lshlrev_b32 v3, 5, v3
    s_cmp_ge_u32 s50, 4
    s_cbranch_scc1 L_c_gu
    s_mov_b32 s58, s50
    s_lshl_b32 s59, s58, 1
    s_add_u32 s59, s59, 2
    s_mov_b32 s62, 1048576
L_w_wq:
    ds_read_b32 v7, v6 offset:256
    s_waitcnt lgkmcnt(0)
    v_readfirstlane_b32 s61, v7
    s_cmp_ge_i32 s61, s59
    s_cbranch_scc1 L_w_wq_done
    s_sleep 1
    s_sub_u32 s62, s62, 1
    s_cmp_lg_u32 s62, 0
    s_cbranch_scc1 L_w_wq
L_w_wq_done:
    s_and_b32 s59, s58, 15
    s_lshl_b32 s60, s59, 13
    v_add_u32 v2, s60, v4
    ds_read_b128 v[72:75], v2 offset:0
    ds_read_b128 v[76:79], v2 offset:1024
    ds_read_b128 v[80:83], v2 offset:2048
    ds_read_b128 v[84:87], v2 offset:3072
    ds_read_b128 v[88:91], v2 offset:4096
    ds_read_b128 v[92:95], v2 offset:5120
    ds_read_b128 v[96:99], v2 offset:6144
    ds_read_b128 v[100:103], v2 offset:7168
    s_and_b32 s59, s58, 15
    s_lshl_b32 s59, s59, 2
    s_add_u32 s59, s59, 131136
    v_mov_b32 v1, s59
    v_mov_b32 v7, 8
    s_waitcnt lgkmcnt(0)
    s_mov_b64 exec, 1
    ds_add_u32 v1, v7
    s_mov_b64 exec, -1
    s_waitcnt vmcnt(0)
    v_perm_b32 v8, v76, v72, s4
    v_perm_b32 v9, v84, v80, s4
    v_perm_b32 v10, v92, v88, s4
    v_perm_b32 v11, v100, v96, s4
    s_nop 1
    v_mfma_f32_16x16x32_bf16 v[104:107], v[16:19], v[8:11], 0
    v_perm_b32 v12, v76, v72, s5
    v_perm_b32 v13, v84, v80, s5
    v_perm_b32 v14, v92, v88, s5
    v_perm_b32 v15, v100, v96, s5
    s_nop 1
    v_mfma_f32_16x16x32_bf16 v[108:111], v[16:19], v[12:15], 0
    v_perm_b32 v8, v77, v73, s4
    v_perm_b32 v9, v85, v81, s4
    v_perm_b32 v10, v93, v89, s4
    v_perm_b32 v11, v101, v97, s4
    s_nop 1
    v_mfma_f32_16x16x32_bf16 v[112:115], v[16:19], v[8:11], 0
    v_perm_b32 v12, v77, v73, s5
    v_perm_b32 v13, v85, v81, s5
    v_perm_b32 v14, v93, v89, s5
    v_perm_b32 v15, v101, v97, s5
    s_nop 1
    v_mfma_f32_16x16x32_bf16 v[116:119], v[16:19], v[12:15], 0
    v_perm_b32 v8, v78, v74, s4
    v_perm_b32 v9, v86, v82, s4
    v_perm_b32 v10, v94, v90, s4
    v_perm_b32 v11, v102, v98, s4
    s_nop 1
    v_mfma_f32_16x16x32_bf16 v[120:123], v[16:19], v[8:11], 0
    v_perm_b32 v12, v78, v74, s5
    v_perm_b32 v13, v86, v82, s5
    v_perm_b32 v14, v94, v90, s5
    v_perm_b32 v15, v102, v98, s5
    s_nop 1
    v_mfma_f32_16x16x32_bf16 v[124:127], v[16:19], v[12:15], 0
    v_perm_b32 v8, v79, v75, s4
    v_perm_b32 v9, v87, v83, s4
    v_perm_b32 v10, v95, v91, s4
    v_perm_b32 v11, v103, v99, s4
    s_nop 1
    v_mfma_f32_16x16x32_bf16 v[128:131], v[16:19], v[8:11], 0
    v_perm_b32 v12, v79, v75, s5
    v_perm_b32 v13, v87, v83, s5
    v_perm_b32 v14, v95, v91, s5
    v_perm_b32 v15, v103, v99, s5
    s_nop 1
    v_mfma_f32_16x16x32_bf16 v[132:135], v[16:19], v[12:15], 0
    s_lshl_b32 s60, s50, 8
    s_add_u32 s60, s60, 131072
    s_nop 7
    v_add_f32_dpp v8, v105, v104 row_ror:8 row_mask:0xf bank_mask:0xf
    v_add_f32_dpp v9, v109, v108 row_ror:8 row_mask:0xf bank_mask:0xf
    v_add_f32_dpp v10, v113, v112 row_ror:8 row_mask:0xf bank_mask:0xf
    v_add_f32_dpp v11, v117, v116 row_ror:8 row_mask:0xf bank_mask:0xf
    v_add_f32_dpp v12, v121, v120 row_ror:8 row_mask:0xf bank_mask:0xf
    v_add_f32_dpp v13, v125, v124 row_ror:8 row_mask:0xf bank_mask:0xf
    v_add_f32_dpp v14, v129, v128 row_ror:8 row_mask:0xf bank_mask:0xf
    v_add_f32_dpp v15, v133, v132 row_ror:8 row_mask:0xf bank_mask:0xf
    v_add_u32 v1, s60, v3
    s_mov_b64 exec, 0xff
    ds_write_b128 v1, v[8:11] offset:512
    ds_write_b128 v1, v[12:15] offset:528
    s_waitcnt lgkmcnt(0)
    s_mov_b64 exec, 1
    v_mov_b32 v7, 1
    ds_add_u32 v6, v7 offset:0
    s_mov_b64 exec, -1
L_c_gu:
    s_xor_b32 s63, s50, 4
    s_add_u32 s58, s63, 4
    s_lshl_b32 s59, s58, 1
    s_add_u32 s59, s59, 2
    s_mov_b32 s62, 1048576
L_w_gu:
    ds_read_b32 v7, v6 offset:256
    s_waitcnt lgkmcnt(0)
    v_readfirstlane_b32 s61, v7
    s_cmp_ge_i32 s61, s59
    s_cbranch_scc1 L_w_gu_done
    s_sleep 1
    s_sub_u32 s62, s62, 1
    s_cmp_lg_u32 s62, 0
    s_cbranch_scc1 L_w_gu
L_w_gu_done:
    s_and_b32 s59, s58, 15
    s_lshl_b32 s60, s59, 13
    v_add_u32 v2, s60, v4
    ds_read_b128 v[72:75], v2 offset:0
    ds_read_b128 v[76:79], v2 offset:1024
    ds_read_b128 v[80:83], v2 offset:2048
    ds_read_b128 v[84:87], v2 offset:3072
    ds_read_b128 v[88:91], v2 offset:4096
    ds_read_b128 v[92:95], v2 offset:5120
    ds_read_b128 v[96:99], v2 offset:6144
    ds_read_b128 v[100:103], v2 offset:7168
    s_and_b32 s59, s58, 15
    s_lshl_b32 s59, s59, 2
    s_add_u32 s59, s59, 131136
    v_mov_b32 v1, s59
    v_mov_b32 v7, 8
    s_waitcnt lgkmcnt(0)
    s_mov_b64 exec, 1
    ds_add_u32 v1, v7
    s_mov_b64 exec, -1
    s_waitcnt vmcnt(0)
    v_perm_b32 v8, v76, v72, s4
    v_perm_b32 v9, v84, v80, s4
    v_perm_b32 v10, v92, v88, s4
    v_perm_b32 v11, v100, v96, s4
    s_nop 1
    v_mfma_f32_16x16x32_bf16 v[104:107], v[16:19], v[8:11], 0
    v_perm_b32 v12, v76, v72, s5
    v_perm_b32 v13, v84, v80, s5
    v_perm_b32 v14, v92, v88, s5
    v_perm_b32 v15, v100, v96, s5
    s_nop 1
    v_mfma_f32_16x16x32_bf16 v[108:111], v[16:19], v[12:15], 0
    v_perm_b32 v8, v77, v73, s4
    v_perm_b32 v9, v85, v81, s4
    v_perm_b32 v10, v93, v89, s4
    v_perm_b32 v11, v101, v97, s4
    s_nop 1
    v_mfma_f32_16x16x32_bf16 v[112:115], v[16:19], v[8:11], 0
    v_perm_b32 v12, v77, v73, s5
    v_perm_b32 v13, v85, v81, s5
    v_perm_b32 v14, v93, v89, s5
    v_perm_b32 v15, v101, v97, s5
    s_nop 1
    v_mfma_f32_16x16x32_bf16 v[116:119], v[16:19], v[12:15], 0
    v_perm_b32 v8, v78, v74, s4
    v_perm_b32 v9, v86, v82, s4
    v_perm_b32 v10, v94, v90, s4
    v_perm_b32 v11, v102, v98, s4
    s_nop 1
    v_mfma_f32_16x16x32_bf16 v[120:123], v[16:19], v[8:11], 0
    v_perm_b32 v12, v78, v74, s5
    v_perm_b32 v13, v86, v82, s5
    v_perm_b32 v14, v94, v90, s5
    v_perm_b32 v15, v102, v98, s5
    s_nop 1
    v_mfma_f32_16x16x32_bf16 v[124:127], v[16:19], v[12:15], 0
    v_perm_b32 v8, v79, v75, s4
    v_perm_b32 v9, v87, v83, s4
    v_perm_b32 v10, v95, v91, s4
    v_perm_b32 v11, v103, v99, s4
    s_nop 1
    v_mfma_f32_16x16x32_bf16 v[128:131], v[16:19], v[8:11], 0
    v_perm_b32 v12, v79, v75, s5
    v_perm_b32 v13, v87, v83, s5
    v_perm_b32 v14, v95, v91, s5
    v_perm_b32 v15, v103, v99, s5
    s_nop 1
    v_mfma_f32_16x16x32_bf16 v[132:135], v[16:19], v[12:15], 0
    s_lshl_b32 s60, s63, 8
    s_add_u32 s60, s60, 131072
    s_nop 7
    v_add_f32_dpp v8, v105, v104 row_ror:8 row_mask:0xf bank_mask:0xf
    v_add_f32_dpp v9, v109, v108 row_ror:8 row_mask:0xf bank_mask:0xf
    v_add_f32_dpp v10, v113, v112 row_ror:8 row_mask:0xf bank_mask:0xf
    v_add_f32_dpp v11, v117, v116 row_ror:8 row_mask:0xf bank_mask:0xf
    v_add_f32_dpp v12, v121, v120 row_ror:8 row_mask:0xf bank_mask:0xf
    v_add_f32_dpp v13, v125, v124 row_ror:8 row_mask:0xf bank_mask:0xf
    v_add_f32_dpp v14, v129, v128 row_ror:8 row_mask:0xf bank_mask:0xf
    v_add_f32_dpp v15, v133, v132 row_ror:8 row_mask:0xf bank_mask:0xf
    v_add_u32 v1, s60, v3
    s_mov_b64 exec, 0xff
    ds_write_b128 v1, v[8:11] offset:1536
    ds_write_b128 v1, v[12:15] offset:1552
    s_waitcnt lgkmcnt(0)
    s_mov_b64 exec, 1
    v_mov_b32 v7, 1
    ds_add_u32 v6, v7 offset:20
    s_mov_b64 exec, -1
    v_and_b32 v1, 15, v0
    v_xor_b32 v7, v1, v5
    s_add_u32 s58, s50, 12
    s_and_b32 s59, s58, 15
    s_lshl_b32 s60, s59, 13
    v_lshl_add_u32 v1, v1, 8, s60
    v_xor_b32 v2, 0, v7
    v_lshl_add_u32 v2, v2, 4, v1
    v_xor_b32 v3, 4, v7
    v_lshl_add_u32 v3, v3, 4, v1
    v_xor_b32 v4, 8, v7
    v_lshl_add_u32 v4, v4, 4, v1
    v_xor_b32 v5, 12, v7
    v_lshl_add_u32 v5, v5, 4, v1
    s_lshl_b32 s59, s58, 1
    s_add_u32 s59, s59, 2
    s_mov_b32 s62, 1048576
L_w_k0:
    ds_read_b32 v7, v6 offset:256
    s_waitcnt lgkmcnt(0)
    v_readfirstlane_b32 s61, v7
    s_cmp_ge_i32 s61, s59
    s_cbranch_scc1 L_w_k0_done
    s_sleep 1
    s_sub_u32 s62, s62, 1
    s_cmp_lg_u32 s62, 0
    s_cbranch_scc1 L_w_k0
L_w_k0_done:
    ds_read_b128 v[40:43], v2 offset:0
    ds_read_b128 v[44:47], v3 offset:0
    ds_read_b128 v[48:51], v4 offset:0
    ds_read_b128 v[52:55], v5 offset:0
    ds_read_b128 v[72:75], v2 offset:4096
    ds_read_b128 v[76:79], v3 offset:4096
    ds_read_b128 v[80:83], v4 offset:4096
    ds_read_b128 v[84:87], v5 offset:4096
    s_and_b32 s59, s58, 15
    s_lshl_b32 s59, s59, 2
    s_add_u32 s59, s59, 131136
    v_mov_b32 v1, s59
    v_mov_b32 v7, 8
    s_waitcnt lgkmcnt(0)
    s_mov_b64 exec, 1
    ds_add_u32 v1, v7
    s_mov_b64 exec, -1
    v_xor_b32 v2, 0x10000, v2
    v_xor_b32 v3, 0x10000, v3
    v_xor_b32 v4, 0x10000, v4
    v_xor_b32 v5, 0x10000, v5
    s_add_u32 s58, s58, 8
    s_lshl_b32 s59, s58, 1
    s_add_u32 s59, s59, 2
    s_mov_b32 s62, 1048576
L_w_k1:
    ds_read_b32 v7, v6 offset:256
    s_waitcnt lgkmcnt(0)
    v_readfirstlane_b32 s61, v7
    s_cmp_ge_i32 s61, s59
    s_cbranch_scc1 L_w_k1_done
    s_sleep 1
    s_sub_u32 s62, s62, 1
    s_cmp_lg_u32 s62, 0
    s_cbranch_scc1 L_w_k1
L_w_k1_done:
    ds_read_b128 v[88:91], v2 offset:0
    ds_read_b128 v[92:95], v3 offset:0
    ds_read_b128 v[96:99], v4 offset:0
    ds_read_b128 v[100:103], v5 offset:0
    ds_read_b128 v[104:107], v2 offset:4096
    ds_read_b128 v[108:111], v3 offset:4096
    ds_read_b128 v[112:115], v4 offset:4096
    ds_read_b128 v[116:119], v5 offset:4096
    s_and_b32 s59, s58, 15
    s_lshl_b32 s59, s59, 2
    s_add_u32 s59, s59, 131136
    v_mov_b32 v1, s59
    v_mov_b32 v7, 8
    s_waitcnt lgkmcnt(0)
    s_mov_b64 exec, 1
    ds_add_u32 v1, v7
    s_mov_b64 exec, -1
    v_xor_b32 v2, 0x10000, v2
    v_xor_b32 v3, 0x10000, v3
    v_xor_b32 v4, 0x10000, v4
    v_xor_b32 v5, 0x10000, v5
    s_add_u32 s58, s58, 8
    s_lshl_b32 s59, s58, 1
    s_add_u32 s59, s59, 2
    s_mov_b32 s62, 1048576
L_w_k2:
    ds_read_b32 v7, v6 offset:256
    s_waitcnt lgkmcnt(0)
    v_readfirstlane_b32 s61, v7
    s_cmp_ge_i32 s61, s59
    s_cbranch_scc1 L_w_k2_done
    s_sleep 1
    s_sub_u32 s62, s62, 1
    s_cmp_lg_u32 s62, 0
    s_cbranch_scc1 L_w_k2
L_w_k2_done:
    ds_read_b128 v[120:123], v2 offset:0
    ds_read_b128 v[124:127], v3 offset:0
    ds_read_b128 v[128:131], v4 offset:0
    ds_read_b128 v[132:135], v5 offset:0
    ds_read_b128 v[136:139], v2 offset:4096
    ds_read_b128 v[140:143], v3 offset:4096
    ds_read_b128 v[144:147], v4 offset:4096
    ds_read_b128 v[148:151], v5 offset:4096
    s_and_b32 s59, s58, 15
    s_lshl_b32 s59, s59, 2
    s_add_u32 s59, s59, 131136
    v_mov_b32 v1, s59
    v_mov_b32 v7, 8
    s_waitcnt lgkmcnt(0)
    s_mov_b64 exec, 1
    ds_add_u32 v1, v7
    s_mov_b64 exec, -1
    v_xor_b32 v2, 0x10000, v2
    v_xor_b32 v3, 0x10000, v3
    v_xor_b32 v4, 0x10000, v4
    v_xor_b32 v5, 0x10000, v5
    s_add_u32 s58, s58, 8
    s_lshl_b32 s59, s58, 1
    s_add_u32 s59, s59, 2
    s_mov_b32 s62, 1048576
L_w_k3:
    ds_read_b32 v7, v6 offset:256
    s_waitcnt lgkmcnt(0)
    v_readfirstlane_b32 s61, v7
    s_cmp_ge_i32 s61, s59
    s_cbranch_scc1 L_w_k3_done
    s_sleep 1
    s_sub_u32 s62, s62, 1
    s_cmp_lg_u32 s62, 0
    s_cbranch_scc1 L_w_k3
L_w_k3_done:
    ds_read_b128 v[152:155], v2 offset:0
    ds_read_b128 v[156:159], v3 offset:0
    ds_read_b128 v[160:163], v4 offset:0
    ds_read_b128 v[164:167], v5 offset:0
    ds_read_b128 v[56:59], v2 offset:4096
    ds_read_b128 v[60:63], v3 offset:4096
    ds_read_b128 v[64:67], v4 offset:4096
    ds_read_b128 v[68:71], v5 offset:4096
    s_and_b32 s59, s58, 15
    s_lshl_b32 s59, s59, 2
    s_add_u32 s59, s59, 131136
    v_mov_b32 v1, s59
    v_mov_b32 v7, 8
    s_waitcnt lgkmcnt(0)
    s_mov_b64 exec, 1
    ds_add_u32 v1, v7
    s_mov_b64 exec, -1
    v_lshrrev_b32 v5, 4, v0
    v_and_b32 v1, 7, v0
    v_lshlrev_b32 v2, 8, v1
    v_lshl_add_u32 v2, v5, 4, v2
    v_add_u32 v2, v2, v6
    v_lshl_add_u32 v3, v1, 5, v6
    s_lshl_b32 s59, s50, 2
    s_mov_b32 s48, 0x3fb8aa3b
    s_mov_b32 s62, 1048576
L_w_fq:
    ds_read_b32 v7, v6 offset:12
    s_waitcnt lgkmcnt(0)
    v_readfirstlane_b32 s61, v7
    s_cmp_ge_i32 s61, 1
    s_cbranch_scc1 L_w_fq_done
    s_sleep 2
    s_sub_u32 s62, s62, 1
    s_cmp_lg_u32 s62, 0
    s_cbranch_scc1 L_w_fq
L_w_fq_done:
    ds_read_b128 v[8:11], v2 offset:3584
    ds_read_b128 v[12:15], v2 offset:3648
    ds_read_b128 v[16:19], v2 offset:3712
    ds_read_b128 v[20:23], v2 offset:3776
    s_waitcnt lgkmcnt(0)
    v_mfma_f32_16x16x32_bf16 v[24:27], v[40:43], v[8:11], 0
    v_mfma_f32_16x16x32_bf16 v[28:31], v[72:75], v[8:11], 0
    v_mfma_f32_16x16x32_bf16 v[24:27], v[44:47], v[12:15], v[24:27]
    v_mfma_f32_16x16x32_bf16 v[28:31], v[76:79], v[12:15], v[28:31]
    v_mfma_f32_16x16x32_bf16 v[24:27], v[48:51], v[16:19], v[24:27]
    v_mfma_f32_16x16x32_bf16 v[28:31], v[80:83], v[16:19], v[28:31]
    v_mfma_f32_16x16x32_bf16 v[24:27], v[52:55], v[20:23], v[24:27]
    v_mfma_f32_16x16x32_bf16 v[28:31], v[84:87], v[20:23], v[28:31]
    v_mfma_f32_16x16x32_bf16 v[32:35], v[88:91], v[8:11], 0
    v_mfma_f32_16x16x32_bf16 v[36:39], v[104:107], v[8:11], 0
    v_mfma_f32_16x16x32_bf16 v[32:35], v[92:95], v[12:15], v[32:35]
    v_mfma_f32_16x16x32_bf16 v[36:39], v[108:111], v[12:15], v[36:39]
    v_mfma_f32_16x16x32_bf16 v[32:35], v[96:99], v[16:19], v[32:35]
    v_mfma_f32_16x16x32_bf16 v[36:39], v[112:115], v[16:19], v[36:39]
    v_mfma_f32_16x16x32_bf16 v[32:35], v[100:103], v[20:23], v[32:35]
    v_mfma_f32_16x16x32_bf16 v[36:39], v[116:119], v[20:23], v[36:39]
    v_mfma_f32_16x16x32_bf16 v[40:43], v[120:123], v[8:11], 0
    v_mfma_f32_16x16x32_bf16 v[44:47], v[136:139], v[8:11], 0
    v_mfma_f32_16x16x32_bf16 v[40:43], v[124:127], v[12:15], v[40:43]
    v_mfma_f32_16x16x32_bf16 v[44:47], v[140:143], v[12:15], v[44:47]
    v_mfma_f32_16x16x32_bf16 v[40:43], v[128:131], v[16:19], v[40:43]
    v_mfma_f32_16x16x32_bf16 v[44:47], v[144:147], v[16:19], v[44:47]
    v_mfma_f32_16x16x32_bf16 v[40:43], v[132:135], v[20:23], v[40:43]
    v_mfma_f32_16x16x32_bf16 v[44:47], v[148:151], v[20:23], v[44:47]
    v_mfma_f32_16x16x32_bf16 v[48:51], v[152:155], v[8:11], 0
    v_mfma_f32_16x16x32_bf16 v[52:55], v[56:59], v[8:11], 0
    v_mfma_f32_16x16x32_bf16 v[48:51], v[156:159], v[12:15], v[48:51]
    v_mfma_f32_16x16x32_bf16 v[52:55], v[60:63], v[12:15], v[52:55]
    v_mfma_f32_16x16x32_bf16 v[48:51], v[160:163], v[16:19], v[48:51]
    v_mfma_f32_16x16x32_bf16 v[52:55], v[64:67], v[16:19], v[52:55]
    v_mfma_f32_16x16x32_bf16 v[48:51], v[164:167], v[20:23], v[48:51]
    v_mfma_f32_16x16x32_bf16 v[52:55], v[68:71], v[20:23], v[52:55]
    s_mov_b32 s49, 0x3db504f3
    v_cvt_pk_bf16_f32 v25, v24, v25
    v_cvt_pk_bf16_f32 v27, v26, v27
    v_cvt_pk_bf16_f32 v29, v28, v29
    v_cvt_pk_bf16_f32 v31, v30, v31
    v_cvt_pk_bf16_f32 v33, v32, v33
    v_cvt_pk_bf16_f32 v35, v34, v35
    v_cvt_pk_bf16_f32 v37, v36, v37
    v_cvt_pk_bf16_f32 v39, v38, v39
    v_cvt_pk_bf16_f32 v41, v40, v41
    v_cvt_pk_bf16_f32 v43, v42, v43
    v_cvt_pk_bf16_f32 v45, v44, v45
    v_cvt_pk_bf16_f32 v47, v46, v47
    v_cvt_pk_bf16_f32 v49, v48, v49
    v_cvt_pk_bf16_f32 v51, v50, v51
    v_cvt_pk_bf16_f32 v53, v52, v53
    v_cvt_pk_bf16_f32 v55, v54, v55
    v_lshlrev_b32 v24, 16, v25
    v_and_b32 v25, 0xffff0000, v25
    v_lshlrev_b32 v26, 16, v27
    v_and_b32 v27, 0xffff0000, v27
    v_lshlrev_b32 v28, 16, v29
    v_and_b32 v29, 0xffff0000, v29
    v_lshlrev_b32 v30, 16, v31
    v_and_b32 v31, 0xffff0000, v31
    v_lshlrev_b32 v32, 16, v33
    v_and_b32 v33, 0xffff0000, v33
    v_lshlrev_b32 v34, 16, v35
    v_and_b32 v35, 0xffff0000, v35
    v_lshlrev_b32 v36, 16, v37
    v_and_b32 v37, 0xffff0000, v37
    v_lshlrev_b32 v38, 16, v39
    v_and_b32 v39, 0xffff0000, v39
    v_lshlrev_b32 v40, 16, v41
    v_and_b32 v41, 0xffff0000, v41
    v_lshlrev_b32 v42, 16, v43
    v_and_b32 v43, 0xffff0000, v43
    v_lshlrev_b32 v44, 16, v45
    v_and_b32 v45, 0xffff0000, v45
    v_lshlrev_b32 v46, 16, v47
    v_and_b32 v47, 0xffff0000, v47
    v_lshlrev_b32 v48, 16, v49
    v_and_b32 v49, 0xffff0000, v49
    v_lshlrev_b32 v50, 16, v51
    v_and_b32 v51, 0xffff0000, v51
    v_lshlrev_b32 v52, 16, v53
    v_and_b32 v53, 0xffff0000, v53
    v_lshlrev_b32 v54, 16, v55
    v_and_b32 v55, 0xffff0000, v55
    v_mul_f32 v24, s49, v24
    v_mul_f32 v25, s49, v25
    v_mul_f32 v26, s49, v26
    v_mul_f32 v27, s49, v27
    v_mul_f32 v28, s49, v28
    v_mul_f32 v29, s49, v29
    v_mul_f32 v30, s49, v30
    v_mul_f32 v31, s49, v31
    v_mul_f32 v32, s49, v32
    v_mul_f32 v33, s49, v33
    v_mul_f32 v34, s49, v34
    v_mul_f32 v35, s49, v35
    v_mul_f32 v36, s49, v36
    v_mul_f32 v37, s49, v37
    v_mul_f32 v38, s49, v38
    v_mul_f32 v39, s49, v39
    v_mul_f32 v40, s49, v40
    v_mul_f32 v41, s49, v41
    v_mul_f32 v42, s49, v42
    v_mul_f32 v43, s49, v43
    v_mul_f32 v44, s49, v44
    v_mul_f32 v45, s49, v45
    v_mul_f32 v46, s49, v46
    v_mul_f32 v47, s49, v47
    v_mul_f32 v48, s49, v48
    v_mul_f32 v49, s49, v49
    v_mul_f32 v50, s49, v50
    v_mul_f32 v51, s49, v51
    v_mul_f32 v52, s49, v52
    v_mul_f32 v53, s49, v53
    v_mul_f32 v54, s49, v54
    v_mul_f32 v55, s49, v55
    v_cvt_pk_bf16_f32 v25, v24, v25
    v_cvt_pk_bf16_f32 v27, v26, v27
    v_cvt_pk_bf16_f32 v29, v28, v29
    v_cvt_pk_bf16_f32 v31, v30, v31
    v_cvt_pk_bf16_f32 v33, v32, v33
    v_cvt_pk_bf16_f32 v35, v34, v35
    v_cvt_pk_bf16_f32 v37, v36, v37
    v_cvt_pk_bf16_f32 v39, v38, v39
    v_cvt_pk_bf16_f32 v41, v40, v41
    v_cvt_pk_bf16_f32 v43, v42, v43
    v_cvt_pk_bf16_f32 v45, v44, v45
    v_cvt_pk_bf16_f32 v47, v46, v47
    v_cvt_pk_bf16_f32 v49, v48, v49
    v_cvt_pk_bf16_f32 v51, v50, v51
    v_cvt_pk_bf16_f32 v53, v52, v53
    v_cvt_pk_bf16_f32 v55, v54, v55
    v_lshlrev_b32 v24, 16, v25
    v_and_b32 v25, 0xffff0000, v25
    v_lshlrev_b32 v26, 16, v27
    v_and_b32 v27, 0xffff0000, v27
    v_lshlrev_b32 v28, 16, v29
    v_and_b32 v29, 0xffff0000, v29
    v_lshlrev_b32 v30, 16, v31
    v_and_b32 v31, 0xffff0000, v31
    v_lshlrev_b32 v32, 16, v33
    v_and_b32 v33, 0xffff0000, v33
    v_lshlrev_b32 v34, 16, v35
    v_and_b32 v35, 0xffff0000, v35
    v_lshlrev_b32 v36, 16, v37
    v_and_b32 v37, 0xffff0000, v37
    v_lshlrev_b32 v38, 16, v39
    v_and_b32 v39, 0xffff0000, v39
    v_lshlrev_b32 v40, 16, v41
    v_and_b32 v41, 0xffff0000, v41
    v_lshlrev_b32 v42, 16, v43
    v_and_b32 v43, 0xffff0000, v43
    v_lshlrev_b32 v44, 16, v45
    v_and_b32 v45, 0xffff0000, v45
    v_lshlrev_b32 v46, 16, v47
    v_and_b32 v47, 0xffff0000, v47
    v_lshlrev_b32 v48, 16, v49
    v_and_b32 v49, 0xffff0000, v49
    v_lshlrev_b32 v50, 16, v51
    v_and_b32 v51, 0xffff0000, v51
    v_lshlrev_b32 v52, 16, v53
    v_and_b32 v53, 0xffff0000, v53
    v_lshlrev_b32 v54, 16, v55
    v_and_b32 v55, 0xffff0000, v55
    v_max3_f32 v4, v24, v25, v26
    v_max3_f32 v2, v27, v28, v29
    v_max3_f32 v4, v4, v30, v31
    v_max3_f32 v2, v2, v32, v33
    v_max3_f32 v4, v4, v34, v35
    v_max3_f32 v2, v2, v36, v37
    v_max3_f32 v4, v4, v38, v39
    v_max3_f32 v2, v2, v40, v41
    v_max3_f32 v4, v4, v42, v43
    v_max3_f32 v2, v2, v44, v45
    s_nop 1
    v_max3_f32 v4, v4, v46, v47
    v_max3_f32 v2, v2, v48, v49
    v_max3_f32 v4, v4, v50, v51
    v_max3_f32 v2, v2, v52, v53
    v_max3_f32 v4, v4, v54, v55
    v_max_f32 v4, v4, v2
    v_mov_b32 v2, v4
    s_nop 1
    v_permlane16_swap_b32 v4, v2
    v_max_f32 v4, v4, v2
    v_mov_b32 v2, v4
    s_nop 1
    v_permlane32_swap_b32 v4, v2
    v_max_f32 v4, v4, v2
    v_add_u32 v2, s59, v3
    s_mov_b64 exec, 0xff
    ds_write_b32 v2, v4 offset:5632
    s_waitcnt lgkmcnt(0)
    s_mov_b64 exec, 1
    v_mov_b32 v7, 1
    ds_add_u32 v6, v7 offset:4
    s_mov_b64 exec, -1
    s_mov_b32 s62, 1048576
L_w_m:
    ds_read_b32 v7, v6 offset:4
    s_waitcnt lgkmcnt(0)
    v_readfirstlane_b32 s61, v7
    s_cmp_ge_i32 s61, 8
    s_cbranch_scc1 L_w_m_done
    s_sleep 1
    s_sub_u32 s62, s62, 1
    s_cmp_lg_u32 s62, 0
    s_cbranch_scc1 L_w_m
L_w_m_done:
    ds_read_b128 v[8:11], v3 offset:5632
    ds_read_b128 v[12:15], v3 offset:5648
    s_waitcnt lgkmcnt(0)
    v_max3_f32 v4, v8, v9, v10
    v_max3_f32 v4, v4, v11, v12
    v_max3_f32 v4, v4, v13, v14
    v_max_f32 v4, v4, v15
    v_mul_f32 v4, s48, v4
    v_fma_f32 v24, v24, s48, -v4
    v_fma_f32 v25, v25, s48, -v4
    v_fma_f32 v26, v26, s48, -v4
    v_fma_f32 v27, v27, s48, -v4
    v_fma_f32 v28, v28, s48, -v4
    v_fma_f32 v29, v29, s48, -v4
    v_fma_f32 v30, v30, s48, -v4
    v_fma_f32 v31, v31, s48, -v4
    v_fma_f32 v32, v32, s48, -v4
    v_fma_f32 v33, v33, s48, -v4
    v_fma_f32 v34, v34, s48, -v4
    v_fma_f32 v35, v35, s48, -v4
    v_fma_f32 v36, v36, s48, -v4
    v_fma_f32 v37, v37, s48, -v4
    v_fma_f32 v38, v38, s48, -v4
    v_fma_f32 v39, v39, s48, -v4
    v_fma_f32 v40, v40, s48, -v4
    v_fma_f32 v41, v41, s48, -v4
    v_fma_f32 v42, v42, s48, -v4
    v_fma_f32 v43, v43, s48, -v4
    v_fma_f32 v44, v44, s48, -v4
    v_fma_f32 v45, v45, s48, -v4
    v_fma_f32 v46, v46, s48, -v4
    v_fma_f32 v47, v47, s48, -v4
    v_fma_f32 v48, v48, s48, -v4
    v_fma_f32 v49, v49, s48, -v4
    v_fma_f32 v50, v50, s48, -v4
    v_fma_f32 v51, v51, s48, -v4
    v_fma_f32 v52, v52, s48, -v4
    v_fma_f32 v53, v53, s48, -v4
    v_fma_f32 v54, v54, s48, -v4
    v_fma_f32 v55, v55, s48, -v4
    v_exp_f32 v24, v24
    v_exp_f32 v25, v25
    v_exp_f32 v26, v26
    v_exp_f32 v27, v27
    v_exp_f32 v28, v28
    v_exp_f32 v29, v29
    v_exp_f32 v30, v30
    v_exp_f32 v31, v31
    v_exp_f32 v32, v32
    v_exp_f32 v33, v33
    v_exp_f32 v34, v34
    v_exp_f32 v35, v35
    v_exp_f32 v36, v36
    v_exp_f32 v37, v37
    v_exp_f32 v38, v38
    v_exp_f32 v39, v39
    v_exp_f32 v40, v40
    v_exp_f32 v41, v41
    v_exp_f32 v42, v42
    v_exp_f32 v43, v43
    v_exp_f32 v44, v44
    v_exp_f32 v45, v45
    v_exp_f32 v46, v46
    v_exp_f32 v47, v47
    v_exp_f32 v48, v48
    v_exp_f32 v49, v49
    v_exp_f32 v50, v50
    v_exp_f32 v51, v51
    v_exp_f32 v52, v52
    v_exp_f32 v53, v53
    v_exp_f32 v54, v54
    v_exp_f32 v55, v55
    v_add_f32 v4, v24, v25
    v_add_f32 v1, v26, v27
    v_add_f32 v4, v4, v28
    v_add_f32 v1, v1, v29
    v_add_f32 v4, v4, v30
    v_add_f32 v1, v1, v31
    v_add_f32 v4, v4, v32
    v_add_f32 v1, v1, v33
    v_add_f32 v4, v4, v34
    v_add_f32 v1, v1, v35
    v_add_f32 v4, v4, v36
    v_add_f32 v1, v1, v37
    v_add_f32 v4, v4, v38
    v_add_f32 v1, v1, v39
    v_add_f32 v4, v4, v40
    v_add_f32 v1, v1, v41
    v_add_f32 v4, v4, v42
    v_add_f32 v1, v1, v43
    v_add_f32 v4, v4, v44
    v_add_f32 v1, v1, v45
    v_add_f32 v4, v4, v46
    v_add_f32 v1, v1, v47
    v_add_f32 v4, v4, v48
    v_add_f32 v1, v1, v49
    v_add_f32 v4, v4, v50
    v_add_f32 v1, v1, v51
    v_add_f32 v4, v4, v52
    v_add_f32 v1, v1, v53
    v_add_f32 v4, v4, v54
    v_add_f32 v1, v1, v55
    v_cvt_pk_bf16_f32 v56, v24, v25
    v_cvt_pk_bf16_f32 v57, v26, v27
    v_cvt_pk_bf16_f32 v58, v28, v29
    v_cvt_pk_bf16_f32 v59, v30, v31
    v_cvt_pk_bf16_f32 v60, v32, v33
    v_cvt_pk_bf16_f32 v61, v34, v35
    v_cvt_pk_bf16_f32 v62, v36, v37
    v_cvt_pk_bf16_f32 v63, v38, v39
    v_cvt_pk_bf16_f32 v64, v40, v41
    v_cvt_pk_bf16_f32 v65, v42, v43
    v_cvt_pk_bf16_f32 v66, v44, v45
    v_cvt_pk_bf16_f32 v67, v46, v47
    v_cvt_pk_bf16_f32 v68, v48, v49
    v_cvt_pk_bf16_f32 v69, v50, v51
    v_cvt_pk_bf16_f32 v70, v52, v53
    v_cvt_pk_bf16_f32 v71, v54, v55
    v_add_f32 v4, v4, v1
    v_mov_b32 v1, v4
    s_nop 1
    v_permlane16_swap_b32 v4, v1
    v_add_f32 v4, v4, v1
    v_mov_b32 v1, v4
    s_nop 1
    v_permlane32_swap_b32 v4, v1
    v_add_f32 v4, v4, v1
    v_and_b32 v1, 7, v0
    v_lshl_add_u32 v20, v1, 4, v6
    v_lshl_add_u32 v20, v5, 7, v20
    s_lshl_b32 s60, s50, 9
    v_add_u32 v1, s60, v20
    s_mov_b32 exec_lo, 0x00ff00ff
    s_mov_b32 exec_hi, 0x00ff00ff
    ds_write_b128 v1, v[56:59] offset:6400
    ds_write_b128 v1, v[60:63] offset:10496
    ds_write_b128 v1, v[64:67] offset:14592
    ds_write_b128 v1, v[68:71] offset:18688
    s_mov_b64 exec, 0xff
    ds_write_b32 v2, v4 offset:5888
    s_waitcnt lgkmcnt(0)
    s_mov_b64 exec, 1
    v_mov_b32 v7, 1
    ds_add_u32 v6, v7 offset:8
    s_mov_b64 exec, -1
    v_bfe_u32 v1, v0, 2, 4
    v_and_b32 v2, 7, v1
    v_xor_b32 v2, s50, v2
    v_lshlrev_b32 v2, 5, v2
    v_lshl_add_u32 v2, v1, 8, v2
    v_and_b32 v1, 3, v0
    v_lshl_add_u32 v2, v1, 3, v2
    v_mov_b32 v24, 0
    v_mov_b32 v25, 0
    v_mov_b32 v26, 0
    v_mov_b32 v27, 0
    v_mov_b32 v23, 1
    v_lshlrev_b32 v4, 4, v0
    v_lshl_add_u32 v3, v5, 4, v6
    s_mov_b32 s58, 44
    s_mov_b32 s62, 1048576
L_w_p:
    ds_read_b32 v7, v6 offset:8
    s_waitcnt lgkmcnt(0)
    v_readfirstlane_b32 s61, v7
    s_cmp_ge_i32 s61, 8
    s_cbranch_scc1 L_w_p_done
    s_sleep 1
    s_sub_u32 s62, s62, 1
    s_cmp_lg_u32 s62, 0
    s_cbranch_scc1 L_w_p
L_w_p_done:
L_c_v2:
L_v2:
    ds_read_b128 v[32:35], v20 offset:6400
    s_and_b32 s63, s58, 15
    s_lshl_b32 s60, s63, 13
    v_add_u32 v21, s60, v2
    s_lshl_b32 s63, s63, 2
    s_add_u32 s63, s63, 131136
    v_mov_b32 v22, s63
    v_add_u32 v20, 512, v20
    s_lshl_b32 s59, s58, 1
    s_add_u32 s59, s59, 2
    s_mov_b32 s62, 1048576
L_v2_w:
    ds_read_b32 v7, v6 offset:256
    s_waitcnt lgkmcnt(0)
    v_readfirstlane_b32 s61, v7
    s_cmp_ge_i32 s61, s59
    s_cbranch_scc1 L_v2_w_done
    s_sleep 1
    s_sub_u32 s62, s62, 1
    s_cmp_lg_u32 s62, 0
    s_cbranch_scc1 L_v2_w
L_v2_w_done:
    ds_read_b64_tr_b16 v[28:29], v21
    ds_read_b64_tr_b16 v[30:31], v21 offset:4096
    s_add_u32 s58, s58, 1
    s_waitcnt lgkmcnt(0)
    v_mfma_f32_16x16x32_bf16 v[24:27], v[28:31], v[32:35], v[24:27]
    s_mov_b64 exec, 1
    ds_add_u32 v22, v23
    s_mov_b64 exec, -1
    s_cmp_lt_u32 s58, 74
    s_cbranch_scc1 L_v2
    v_and_b32 v1, 7, v0
    v_lshl_add_u32 v36, v1, 2, v6
    v_lshlrev_b32 v37, 6, v1
    v_lshl_add_u32 v37, v5, 4, v37
    s_lshl_b32 s68, s2, 12
    s_lshl_b32 s60, s50, 9
    s_add_u32 s68, s68, s60
    s_add_u32 s68, s68, 262144
    v_mov_b32 v38, 0xff
    s_setprio 2
    s_mov_b32 s62, 1048576
L_w_ff:
    ds_read_b32 v7, v6 offset:32
    s_waitcnt lgkmcnt(0)
    v_readfirstlane_b32 s61, v7
    s_cmp_ge_i32 s61, 1
    s_cbranch_scc1 L_w_ff_done
    s_sleep 1
    s_sub_u32 s62, s62, 1
    s_cmp_lg_u32 s62, 0
    s_cbranch_scc1 L_w_ff
L_w_ff_done:
    ds_read_b32 v36, v36 offset:6144
L_v3:
    ds_read_b128 v[32:35], v20 offset:6400
    s_and_b32 s63, s58, 15
    s_lshl_b32 s60, s63, 13
    v_add_u32 v21, s60, v2
    s_lshl_b32 s63, s63, 2
    s_add_u32 s63, s63, 131136
    v_mov_b32 v22, s63
    v_add_u32 v20, 512, v20
    s_lshl_b32 s59, s58, 1
    s_add_u32 s59, s59, 2
    s_mov_b32 s62, 1048576
L_v3_w:
    ds_read_b32 v7, v6 offset:256
    s_waitcnt lgkmcnt(0)
    v_readfirstlane_b32 s61, v7
    s_cmp_ge_i32 s61, s59
    s_cbranch_scc1 L_v3_w_done
    s_sub_u32 s62, s62, 1
    s_cmp_lg_u32 s62, 0
    s_cbranch_scc1 L_v3_w
L_v3_w_done:
    ds_read_b64_tr_b16 v[28:29], v21
    ds_read_b64_tr_b16 v[30:31], v21 offset:4096
    s_add_u32 s58, s58, 1
    s_waitcnt lgkmcnt(0)
    v_mfma_f32_16x16x32_bf16 v[24:27], v[28:31], v[32:35], v[24:27]
    s_mov_b64 exec, 1
    ds_add_u32 v22, v23
    s_mov_b64 exec, -1
    s_cmp_lt_u32 s58, 76
    s_cbranch_scc1 L_v3
    s_mov_b32 exec_lo, 0x00ff00ff
    s_mov_b32 exec_hi, 0x00ff00ff
    s_nop 0
    v_mul_f32 v24, v24, v36
    v_mul_f32 v25, v25, v36
    v_mul_f32 v26, v26, v36
    v_mul_f32 v27, v27, v36
    v_bfi_b32 v24, v38, s32, v24
    v_bfi_b32 v25, v38, s33, v25
    v_bfi_b32 v26, v38, s34, v26
    v_bfi_b32 v27, v38, s35, v27
    buffer_store_dwordx4 v[24:27], v37, s[16:19], s68 offen sc1
    s_mov_b64 exec, -1
    s_cmp_lt_u32 s50, 4
    s_cbranch_scc1 L_c_wo
    s_endpgm
L_c_wo:
    s_add_u32 s58, s50, 76
    s_lshl_b32 s59, s58, 1
    s_add_u32 s59, s59, 2
    s_mov_b32 s62, 1048576
L_w_wd:
    ds_read_b32 v7, v6 offset:256
    s_waitcnt lgkmcnt(0)
    v_readfirstlane_b32 s61, v7
    s_cmp_ge_i32 s61, s59
    s_cbranch_scc1 L_w_wd_done
    s_sleep 1
    s_sub_u32 s62, s62, 1
    s_cmp_lg_u32 s62, 0
    s_cbranch_scc1 L_w_wd
L_w_wd_done:
    s_and_b32 s59, s58, 15
    s_lshl_b32 s60, s59, 13
    v_add_u32 v21, s60, v4
    ds_read_b128 v[72:75], v21 offset:0
    ds_read_b128 v[76:79], v21 offset:1024
    ds_read_b128 v[80:83], v21 offset:2048
    ds_read_b128 v[84:87], v21 offset:3072
    ds_read_b128 v[88:91], v21 offset:4096
    ds_read_b128 v[92:95], v21 offset:5120
    ds_read_b128 v[96:99], v21 offset:6144
    ds_read_b128 v[100:103], v21 offset:7168
    s_and_b32 s59, s58, 15
    s_lshl_b32 s59, s59, 2
    s_add_u32 s59, s59, 131136
    v_mov_b32 v1, s59
    v_mov_b32 v7, 8
    s_waitcnt lgkmcnt(0)
    s_mov_b64 exec, 1
    ds_add_u32 v1, v7
    s_mov_b64 exec, -1
    s_mov_b32 s62, 1048576
L_w_fh:
    ds_read_b32 v7, v6 offset:24
    s_waitcnt lgkmcnt(0)
    v_readfirstlane_b32 s61, v7
    s_cmp_ge_i32 s61, 1
    s_cbranch_scc1 L_w_fh_done
    s_sleep 2
    s_sub_u32 s62, s62, 1
    s_cmp_lg_u32 s62, 0
    s_cbranch_scc1 L_w_fh
L_w_fh_done:
    ds_read_b128 v[16:19], v3 offset:192
    ds_read_b64 v[136:137], v6 offset:40
    s_waitcnt lgkmcnt(0)
    v_readfirstlane_b32 s48, v136
    v_readfirstlane_b32 s49, v137
    v_perm_b32 v8, v76, v72, s4
    v_perm_b32 v9, v84, v80, s4
    v_perm_b32 v10, v92, v88, s4
    v_perm_b32 v11, v100, v96, s4
    s_nop 1
    v_mfma_f32_16x16x32_bf16 v[104:107], v[16:19], v[8:11], 0
    v_perm_b32 v12, v76, v72, s5
    v_perm_b32 v13, v84, v80, s5
    v_perm_b32 v14, v92, v88, s5
    v_perm_b32 v15, v100, v96, s5
    s_nop 1
    v_mfma_f32_16x16x32_bf16 v[108:111], v[16:19], v[12:15], 0
    v_perm_b32 v8, v77, v73, s4
    v_perm_b32 v9, v85, v81, s4
    v_perm_b32 v10, v93, v89, s4
    v_perm_b32 v11, v101, v97, s4
    s_nop 1
    v_mfma_f32_16x16x32_bf16 v[112:115], v[16:19], v[8:11], 0
    v_perm_b32 v12, v77, v73, s5
    v_perm_b32 v13, v85, v81, s5
    v_perm_b32 v14, v93, v89, s5
    v_perm_b32 v15, v101, v97, s5
    s_nop 1
    v_mfma_f32_16x16x32_bf16 v[116:119], v[16:19], v[12:15], 0
    v_perm_b32 v8, v78, v74, s4
    v_perm_b32 v9, v86, v82, s4
    v_perm_b32 v10, v94, v90, s4
    v_perm_b32 v11, v102, v98, s4
    s_nop 1
    v_mfma_f32_16x16x32_bf16 v[120:123], v[16:19], v[8:11], 0
    v_perm_b32 v12, v78, v74, s5
    v_perm_b32 v13, v86, v82, s5
    v_perm_b32 v14, v94, v90, s5
    v_perm_b32 v15, v102, v98, s5
    s_nop 1
    v_mfma_f32_16x16x32_bf16 v[124:127], v[16:19], v[12:15], 0
    v_perm_b32 v8, v79, v75, s4
    v_perm_b32 v9, v87, v83, s4
    v_perm_b32 v10, v95, v91, s4
    v_perm_b32 v11, v103, v99, s4
    s_nop 1
    v_mfma_f32_16x16x32_bf16 v[128:131], v[16:19], v[8:11], 0
    v_perm_b32 v12, v79, v75, s5
    v_perm_b32 v13, v87, v83, s5
    v_perm_b32 v14, v95, v91, s5
    v_perm_b32 v15, v103, v99, s5
    s_nop 1
    v_mfma_f32_16x16x32_bf16 v[132:135], v[16:19], v[12:15], 0
    v_cmp_eq_u32 s[66:67], 1, v5
    s_nop 6
    v_cndmask_b32 v136, v104, v120, s[66:67]
    v_mul_f32 v136, s49, v136
    v_cndmask_b32 v137, v108, v124, s[66:67]
    v_mul_f32 v137, s49, v137
    v_cndmask_b32 v138, v112, v128, s[66:67]
    v_mul_f32 v138, s49, v138
    v_cndmask_b32 v139, v116, v132, s[66:67]
    v_mul_f32 v139, s49, v139
    s_add_u32 s58, s50, 80
    v_and_b32 v1, 15, v0
    v_lshlrev_b32 v1, 5, v1
    v_lshl_add_u32 v37, v5, 4, v1
    s_lshl_b32 s65, s2, 11
    s_lshl_b32 s60, s50, 9
    s_add_u32 s65, s65, s60
    s_add_u32 s65, s65, 1310720
    s_lshl_b32 s60, s50, 13
    v_add_u32 v2, s60, v4
    s_lshl_b32 s59, s58, 1
    s_add_u32 s59, s59, 2
    s_mov_b32 s62, 1048576
L_w_wo:
    ds_read_b32 v7, v6 offset:256
    s_waitcnt lgkmcnt(0)
    v_readfirstlane_b32 s61, v7
    s_cmp_ge_i32 s61, s59
    s_cbranch_scc1 L_w_wo_done
    s_sub_u32 s62, s62, 1
    s_cmp_lg_u32 s62, 0
    s_cbranch_scc1 L_w_wo
L_w_wo_done:
    ds_read_b128 v[72:75], v2 offset:0
    ds_read_b128 v[76:79], v2 offset:1024
    ds_read_b128 v[80:83], v2 offset:2048
    ds_read_b128 v[84:87], v2 offset:3072
    ds_read_b128 v[88:91], v2 offset:4096
    ds_read_b128 v[92:95], v2 offset:5120
    ds_read_b128 v[96:99], v2 offset:6144
    ds_read_b128 v[100:103], v2 offset:7168
    s_waitcnt lgkmcnt(0)
    v_perm_b32 v104, v76, v72, s4
    v_perm_b32 v105, v84, v80, s4
    v_perm_b32 v106, v92, v88, s4
    v_perm_b32 v107, v100, v96, s4
    v_perm_b32 v108, v76, v72, s5
    v_perm_b32 v109, v84, v80, s5
    v_perm_b32 v110, v92, v88, s5
    v_perm_b32 v111, v100, v96, s5
    v_perm_b32 v112, v77, v73, s4
    v_perm_b32 v113, v85, v81, s4
    v_perm_b32 v114, v93, v89, s4
    v_perm_b32 v115, v101, v97, s4
    v_perm_b32 v116, v77, v73, s5
    v_perm_b32 v117, v85, v81, s5
    v_perm_b32 v118, v93, v89, s5
    v_perm_b32 v119, v101, v97, s5
    v_perm_b32 v120, v78, v74, s4
    v_perm_b32 v121, v86, v82, s4
    v_perm_b32 v122, v94, v90, s4
    v_perm_b32 v123, v102, v98, s4
    v_perm_b32 v124, v78, v74, s5
    v_perm_b32 v125, v86, v82, s5
    v_perm_b32 v126, v94, v90, s5
    v_perm_b32 v127, v102, v98, s5
    v_perm_b32 v128, v79, v75, s4
    v_perm_b32 v129, v87, v83, s4
    v_perm_b32 v130, v95, v91, s4
    v_perm_b32 v131, v103, v99, s4
    v_perm_b32 v132, v79, v75, s5
    v_perm_b32 v133, v87, v83, s5
    v_perm_b32 v134, v95, v91, s5
    v_perm_b32 v135, v103, v99, s5
    s_mov_b32 s62, 1048576
L_w_fob:
    ds_read_b32 v7, v6 offset:28
    ds_read_b128 v[16:19], v3 offset:128
    s_sub_u32 s62, s62, 1
    s_waitcnt lgkmcnt(0)
    v_cmp_ne_u32 vcc, 0, v7
    s_cbranch_vccnz L_w_fob_done
    s_cmp_lg_u32 s62, 0
    s_cbranch_scc1 L_w_fob
L_w_fob_done:
    v_mfma_f32_16x16x32_bf16 v[40:43], v[16:19], v[104:107], 0
    v_mfma_f32_16x16x32_bf16 v[56:59], v[16:19], v[120:123], 0
    v_mfma_f32_16x16x32_bf16 v[44:47], v[16:19], v[108:111], 0
    v_mfma_f32_16x16x32_bf16 v[60:63], v[16:19], v[124:127], 0
    v_mfma_f32_16x16x32_bf16 v[48:51], v[16:19], v[112:115], 0
    v_mfma_f32_16x16x32_bf16 v[64:67], v[16:19], v[128:131], 0
    v_mfma_f32_16x16x32_bf16 v[52:55], v[16:19], v[116:119], 0
    v_mfma_f32_16x16x32_bf16 v[68:71], v[16:19], v[132:135], 0
    s_nop 1
    v_cndmask_b32 v40, v40, v56, s[66:67]
    v_fmac_f32 v136, s48, v40
    v_cndmask_b32 v44, v44, v60, s[66:67]
    v_fmac_f32 v137, s48, v44
    v_cndmask_b32 v48, v48, v64, s[66:67]
    v_fmac_f32 v138, s48, v48
    s_nop 0
    v_cndmask_b32 v52, v52, v68, s[66:67]
    v_fmac_f32 v139, s48, v52
    v_bfi_b32 v136, v38, s32, v136
    v_bfi_b32 v137, v38, s33, v137
    v_bfi_b32 v138, v38, s34, v138
    v_bfi_b32 v139, v38, s35, v139
    s_mov_b32 exec_hi, 0
    buffer_store_dwordx4 v[136:139], v37, s[16:19], s65 offen sc1
    s_endpgm
L_aux:
    v_and_b32 v2, 7, v0
    v_lshlrev_b32 v2, 4, v2
    v_lshrrev_b32 v3, 3, v0
    v_lshrrev_b32 v5, 4, v0
    v_mov_b32 v4, 0xff
    s_cmp_eq_u32 s3, 2
    s_cbranch_scc1 L_a2
    v_lshlrev_b32 v9, 4, v0
    v_add_u32 v8, v9, v6
    s_lshl_b32 s60, s2, 8
    s_add_u32 s60, s60, 2097152
    s_mov_b32 s62, 1048576
L_spin_q:
    ds_read_b32 v7, v6 offset:0
    s_waitcnt lgkmcnt(0)
    v_readfirstlane_b32 s61, v7
    s_cmp_ge_i32 s61, 4
    s_cbranch_scc1 L_spin_q_done
    s_sleep 1
    s_sub_u32 s62, s62, 1
    s_cmp_lg_u32 s62, 0
    s_cbranch_scc1 L_spin_q
L_spin_q_done:
    s_mov_b64 exec, 0xffff
    ds_read_b128 v[40:43], v8 offset:512
    ds_read_b128 v[44:47], v8 offset:768
    ds_read_b128 v[48:51], v8 offset:1024
    ds_read_b128 v[52:55], v8 offset:1280
    s_waitcnt lgkmcnt(0)
    v_pk_add_f32 v[40:41], v[40:41], v[44:45]
    v_pk_add_f32 v[48:49], v[48:49], v[52:53]
    v_pk_add_f32 v[42:43], v[42:43], v[46:47]
    v_pk_add_f32 v[50:51], v[50:51], v[54:55]
    v_pk_add_f32 v[40:41], v[40:41], v[48:49]
    v_pk_add_f32 v[42:43], v[42:43], v[50:51]
    v_bfi_b32 v40, v4, s32, v40
    v_bfi_b32 v41, v4, s33, v41
    v_bfi_b32 v42, v4, s34, v42
    v_bfi_b32 v43, v4, s35, v43
    buffer_store_dwordx4 v[40:43], v9, s[16:19], s60 offen sc1
    s_mov_b64 exec, -1
    s_lshl_b32 s60, s52, 14
    s_add_u32 s60, s60, 2097152
    v_and_b32 v9, 15, v0
    v_lshlrev_b32 v9, 4, v9
    v_lshl_add_u32 v9, v5, 10, v9
    s_mov_b32 s62, 1048576
L_spin_tq:
    ds_read_b32 v7, v6 offset:256
    s_waitcnt lgkmcnt(0)
    v_readfirstlane_b32 s61, v7
    s_cmp_ge_i32 s61, 68
    s_cbranch_scc1 L_spin_tq_done
    s_sleep 8
    s_sub_u32 s62, s62, 1
    s_cmp_lg_u32 s62, 0
    s_cbranch_scc1 L_spin_tq
L_spin_tq_done:
    s_mov_b32 s62, 1048576
L_gath_q:
    s_add_u32 s61, s60, 0
    buffer_load_dwordx4 v[72:75], v9, s[16:19], s61 offen offset:0 sc1
    buffer_load_dwordx4 v[76:79], v9, s[16:19], s61 offen offset:256 sc1
    buffer_load_dwordx4 v[80:83], v9, s[16:19], s61 offen offset:512 sc1
    buffer_load_dwordx4 v[84:87], v9, s[16:19], s61 offen offset:768 sc1
    s_add_u32 s61, s60, 4096
    buffer_load_dwordx4 v[88:91], v9, s[16:19], s61 offen offset:0 sc1
    buffer_load_dwordx4 v[92:95], v9, s[16:19], s61 offen offset:256 sc1
    buffer_load_dwordx4 v[96:99], v9, s[16:19], s61 offen offset:512 sc1
    buffer_load_dwordx4 v[100:103], v9, s[16:19], s61 offen offset:768 sc1
    s_add_u32 s61, s60, 8192
    buffer_load_dwordx4 v[104:107], v9, s[16:19], s61 offen offset:0 sc1
    buffer_load_dwordx4 v[108:111], v9, s[16:19], s61 offen offset:256 sc1
    buffer_load_dwordx4 v[112:115], v9, s[16:19], s61 offen offset:512 sc1
    buffer_load_dwordx4 v[116:119], v9, s[16:19], s61 offen offset:768 sc1
    s_add_u32 s61, s60, 12288
    buffer_load_dwordx4 v[120:123], v9, s[16:19], s61 offen offset:0 sc1
    buffer_load_dwordx4 v[124:127], v9, s[16:19], s61 offen offset:256 sc1
    buffer_load_dwordx4 v[128:131], v9, s[16:19], s61 offen offset:512 sc1
    buffer_load_dwordx4 v[132:135], v9, s[16:19], s61 offen offset:768 sc1
    s_waitcnt vmcnt(12)
    v_xor_b32 v72, s32, v72
    v_xor_b32 v73, s33, v73
    v_xor_b32 v74, s34, v74
    v_xor_b32 v75, s35, v75
    v_xor_b32 v76, s32, v76
    v_xor_b32 v77, s33, v77
    v_xor_b32 v78, s34, v78
    v_xor_b32 v79, s35, v79
    v_xor_b32 v80, s32, v80
    v_xor_b32 v81, s33, v81
    v_xor_b32 v82, s34, v82
    v_xor_b32 v83, s35, v83
    v_xor_b32 v84, s32, v84
    v_xor_b32 v85, s33, v85
    v_xor_b32 v86, s34, v86
    v_xor_b32 v87, s35, v87
    v_or_b32 v1, v72, v73
    v_or3_b32 v1, v1, v74, v75
    v_or3_b32 v1, v1, v76, v77
    v_or3_b32 v1, v1, v78, v79
    v_or3_b32 v1, v1, v80, v81
    v_or3_b32 v1, v1, v82, v83
    v_or3_b32 v1, v1, v84, v85
    v_or3_b32 v1, v1, v86, v87
    v_pk_add_f32 v[72:73], v[72:73], v[76:77]
    v_pk_add_f32 v[80:81], v[80:81], v[84:85]
    v_pk_add_f32 v[74:75], v[74:75], v[78:79]
    v_pk_add_f32 v[82:83], v[82:83], v[86:87]
    v_pk_add_f32 v[72:73], v[72:73], v[80:81]
    v_pk_add_f32 v[74:75], v[74:75], v[82:83]
    v_cvt_pk_bf16_f32 v16, v72, v73
    v_cvt_pk_bf16_f32 v17, v74, v75
    s_waitcnt vmcnt(8)
    v_xor_b32 v88, s32, v88
    v_xor_b32 v89, s33, v89
    v_xor_b32 v90, s34, v90
    v_xor_b32 v91, s35, v91
    v_xor_b32 v92, s32, v92
    v_xor_b32 v93, s33, v93
    v_xor_b32 v94, s34, v94
    v_xor_b32 v95, s35, v95
    v_xor_b32 v96, s32, v96
    v_xor_b32 v97, s33, v97
    v_xor_b32 v98, s34, v98
    v_xor_b32 v99, s35, v99
    v_xor_b32 v100, s32, v100
    v_xor_b32 v101, s33, v101
    v_xor_b32 v102, s34, v102
    v_xor_b32 v103, s35, v103
    v_or3_b32 v1, v1, v88, v89
    v_or3_b32 v1, v1, v90, v91
    v_or3_b32 v1, v1, v92, v93
    v_or3_b32 v1, v1, v94, v95
    v_or3_b32 v1, v1, v96, v97
    v_or3_b32 v1, v1, v98, v99
    v_or3_b32 v1, v1, v100, v101
    v_or3_b32 v1, v1, v102, v103
    v_pk_add_f32 v[88:89], v[88:89], v[92:93]
    v_pk_add_f32 v[96:97], v[96:97], v[100:101]
    v_pk_add_f32 v[90:91], v[90:91], v[94:95]
    v_pk_add_f32 v[98:99], v[98:99], v[102:103]
    v_pk_add_f32 v[88:89], v[88:89], v[96:97]
    v_pk_add_f32 v[90:91], v[90:91], v[98:99]
    v_cvt_pk_bf16_f32 v18, v88, v89
    v_cvt_pk_bf16_f32 v19, v90, v91
    s_waitcnt vmcnt(4)
    v_xor_b32 v104, s32, v104
    v_xor_b32 v105, s33, v105
    v_xor_b32 v106, s34, v106
    v_xor_b32 v107, s35, v107
    v_xor_b32 v108, s32, v108
    v_xor_b32 v109, s33, v109
    v_xor_b32 v110, s34, v110
    v_xor_b32 v111, s35, v111
    v_xor_b32 v112, s32, v112
    v_xor_b32 v113, s33, v113
    v_xor_b32 v114, s34, v114
    v_xor_b32 v115, s35, v115
    v_xor_b32 v116, s32, v116
    v_xor_b32 v117, s33, v117
    v_xor_b32 v118, s34, v118
    v_xor_b32 v119, s35, v119
    v_or3_b32 v1, v1, v104, v105
    v_or3_b32 v1, v1, v106, v107
    v_or3_b32 v1, v1, v108, v109
    v_or3_b32 v1, v1, v110, v111
    v_or3_b32 v1, v1, v112, v113
    v_or3_b32 v1, v1, v114, v115
    v_or3_b32 v1, v1, v116, v117
    v_or3_b32 v1, v1, v118, v119
    v_pk_add_f32 v[104:105], v[104:105], v[108:109]
    v_pk_add_f32 v[112:113], v[112:113], v[116:117]
    v_pk_add_f32 v[106:107], v[106:107], v[110:111]
    v_pk_add_f32 v[114:115], v[114:115], v[118:119]
    v_pk_add_f32 v[104:105], v[104:105], v[112:113]
    v_pk_add_f32 v[106:107], v[106:107], v[114:115]
    v_cvt_pk_bf16_f32 v20, v104, v105
    v_cvt_pk_bf16_f32 v21, v106, v107
    s_waitcnt vmcnt(0)
    v_xor_b32 v120, s32, v120
    v_xor_b32 v121, s33, v121
    v_xor_b32 v122, s34, v122
    v_xor_b32 v123, s35, v123
    v_xor_b32 v124, s32, v124
    v_xor_b32 v125, s33, v125
    v_xor_b32 v126, s34, v126
    v_xor_b32 v127, s35, v127
    v_xor_b32 v128, s32, v128
    v_xor_b32 v129, s33, v129
    v_xor_b32 v130, s34, v130
    v_xor_b32 v131, s35, v131
    v_xor_b32 v132, s32, v132
    v_xor_b32 v133, s33, v133
    v_xor_b32 v134, s34, v134
    v_xor_b32 v135, s35, v135
    v_or3_b32 v1, v1, v120, v121
    v_or3_b32 v1, v1, v122, v123
    v_or3_b32 v1, v1, v124, v125
    v_or3_b32 v1, v1, v126, v127
    v_or3_b32 v1, v1, v128, v129
    v_or3_b32 v1, v1, v130, v131
    v_or3_b32 v1, v1, v132, v133
    v_or3_b32 v1, v1, v134, v135
    v_pk_add_f32 v[120:121], v[120:121], v[124:125]
    v_pk_add_f32 v[128:129], v[128:129], v[132:133]
    v_pk_add_f32 v[122:123], v[122:123], v[126:127]
    v_pk_add_f32 v[130:131], v[130:131], v[134:135]
    v_pk_add_f32 v[120:121], v[120:121], v[128:129]
    v_pk_add_f32 v[122:123], v[122:123], v[130:131]
    v_cvt_pk_bf16_f32 v22, v120, v121
    v_cvt_pk_bf16_f32 v23, v122, v123
    v_and_b32 v1, 0xff, v1
    v_cmp_ne_u32 vcc, 0, v1
    s_cbranch_vccz L_gath_q_done
    s_sub_u32 s62, s62, 1
    s_cmp_lg_u32 s62, 0
    s_cbranch_scc1 L_gath_q
L_gath_q_done:
    v_lshl_add_u32 v8, v0, 3, v6
    ds_write_b64 v8, v[16:17] offset:3584
    ds_write_b64 v8, v[18:19] offset:4096
    ds_write_b64 v8, v[20:21] offset:4608
    ds_write_b64 v8, v[22:23] offset:5120
    s_waitcnt lgkmcnt(0)
    s_mov_b64 exec, 1
    v_mov_b32 v7, 1
    ds_add_u32 v6, v7 offset:12
    s_mov_b64 exec, -1
    v_lshl_add_u32 v8, v2, 1, v6
    s_mov_b32 s48, 0x3fb8aa3b
    s_lshl_b32 s50, s2, 7
    s_add_u32 s50, s50, 196608
    s_mov_b32 s62, 1048576
L_spin_p:
    ds_read_b32 v7, v6 offset:8
    s_waitcnt lgkmcnt(0)
    v_readfirstlane_b32 s61, v7
    s_cmp_ge_i32 s61, 8
    s_cbranch_scc1 L_spin_p_done
    s_sleep 2
    s_sub_u32 s62, s62, 1
    s_cmp_lg_u32 s62, 0
    s_cbranch_scc1 L_spin_p
L_spin_p_done:
    ds_read_b128 v[40:43], v8 offset:5632
    ds_read_b128 v[44:47], v8 offset:5648
    ds_read_b128 v[48:51], v8 offset:5888
    ds_read_b128 v[52:55], v8 offset:5904
    s_waitcnt lgkmcnt(0)
    v_max3_f32 v24, v40, v41, v42
    v_max3_f32 v24, v24, v43, v44
    v_max3_f32 v24, v24, v45, v46
    v_max_f32 v24, v24, v47
    v_mul_f32 v24, s48, v24
    v_add_f32 v25, v48, v49
    v_add_f32 v25, v25, v50
    v_add_f32 v25, v25, v51
    v_add_f32 v25, v25, v52
    v_add_f32 v25, v25, v53
    v_add_f32 v25, v25, v54
    v_add_f32 v25, v25, v55
    v_mov_b32 v26, s6
    v_mov_b32 v27, s7
    v_lshlrev_b32 v9, 4, v0
    s_mov_b64 exec, 0xff
    buffer_store_dwordx4 v[24:27], v9, s[16:19], s50 offen sc1
    s_mov_b64 exec, -1
    s_lshl_b32 s60, s52, 13
    s_add_u32 s60, s60, 196608
    s_add_u32 s63, s60, 4096
    s_mov_b32 s62, 1048576
L_spin_tml:
    ds_read_b32 v7, v6 offset:256
    s_waitcnt lgkmcnt(0)
    v_readfirstlane_b32 s61, v7
    s_cmp_ge_i32 s61, 132
    s_cbranch_scc1 L_spin_tml_done
    s_sleep 8
    s_sub_u32 s62, s62, 1
    s_cmp_lg_u32 s62, 0
    s_cbranch_scc1 L_spin_tml
L_spin_tml_done:
    s_mov_b32 s62, 1048576
L_poll_ml:
    buffer_load_dwordx4 v[72:75], v9, s[16:19], s60 offen offset:0 sc1
    buffer_load_dwordx4 v[76:79], v9, s[16:19], s60 offen offset:1024 sc1
    buffer_load_dwordx4 v[80:83], v9, s[16:19], s60 offen offset:2048 sc1
    buffer_load_dwordx4 v[84:87], v9, s[16:19], s60 offen offset:3072 sc1
    buffer_load_dwordx4 v[88:91], v9, s[16:19], s63 offen offset:0 sc1
    buffer_load_dwordx4 v[92:95], v9, s[16:19], s63 offen offset:1024 sc1
    buffer_load_dwordx4 v[96:99], v9, s[16:19], s63 offen offset:2048 sc1
    buffer_load_dwordx4 v[100:103], v9, s[16:19], s63 offen offset:3072 sc1
    s_waitcnt vmcnt(0)
    v_cmp_ne_u64 vcc, s[6:7], v[74:75]
    v_cmp_ne_u64 s[66:67], s[6:7], v[78:79]
    s_or_b64 vcc, vcc, s[66:67]
    v_cmp_ne_u64 s[66:67], s[6:7], v[82:83]
    s_or_b64 vcc, vcc, s[66:67]
    v_cmp_ne_u64 s[66:67], s[6:7], v[86:87]
    s_or_b64 vcc, vcc, s[66:67]
    v_cmp_ne_u64 s[66:67], s[6:7], v[90:91]
    s_or_b64 vcc, vcc, s[66:67]
    v_cmp_ne_u64 s[66:67], s[6:7], v[94:95]
    s_or_b64 vcc, vcc, s[66:67]
    v_cmp_ne_u64 s[66:67], s[6:7], v[98:99]
    s_or_b64 vcc, vcc, s[66:67]
    v_cmp_ne_u64 s[66:67], s[6:7], v[102:103]
    s_or_b64 vcc, vcc, s[66:67]
    s_cbranch_scc0 L_poll_ml_done
    s_sleep 8
    s_sub_u32 s62, s62, 1
    s_cmp_lg_u32 s62, 0
    s_cbranch_scc1 L_poll_ml
L_poll_ml_done:
    v_max3_f32 v10, v72, v76, v80
    v_max3_f32 v10, v10, v84, v88
    v_max3_f32 v10, v10, v92, v96
    v_max_f32 v10, v10, v100
    s_nop 1
    v_max_f32_dpp v10, v10, v10 row_ror:8 row_mask:0xf bank_mask:0xf
    v_mov_b32 v1, v10
    s_nop 1
    v_permlane16_swap_b32 v10, v1
    v_max_f32 v10, v10, v1
    v_mov_b32 v1, v10
    s_nop 1
    v_permlane32_swap_b32 v10, v1
    v_max_f32 v10, v10, v1
    v_sub_f32 v72, v72, v10
    v_sub_f32 v76, v76, v10
    v_sub_f32 v80, v80, v10
    v_sub_f32 v84, v84, v10
    v_sub_f32 v88, v88, v10
    v_sub_f32 v92, v92, v10
    v_sub_f32 v96, v96, v10
    v_sub_f32 v100, v100, v10
    v_sub_f32 v24, v24, v10
    v_exp_f32 v72, v72
    v_exp_f32 v76, v76
    v_exp_f32 v80, v80
    v_exp_f32 v84, v84
    v_exp_f32 v88, v88
    v_exp_f32 v92, v92
    v_exp_f32 v96, v96
    v_exp_f32 v100, v100
    v_exp_f32 v24, v24
    v_mul_f32 v11, v72, v73
    v_fmac_f32 v11, v76, v77
    v_fmac_f32 v11, v80, v81
    v_fmac_f32 v11, v84, v85
    v_fmac_f32 v11, v88, v89
    v_fmac_f32 v11, v92, v93
    v_fmac_f32 v11, v96, v97
    v_fmac_f32 v11, v100, v101
    s_nop 1
    v_add_f32_dpp v11, v11, v11 row_ror:8 row_mask:0xf bank_mask:0xf
    v_mov_b32 v1, v11
    s_nop 1
    v_permlane16_swap_b32 v11, v1
    v_add_f32 v11, v11, v1
    v_mov_b32 v1, v11
    s_nop 1
    v_permlane32_swap_b32 v11, v1
    v_add_f32 v11, v11, v1
    v_rcp_f32 v11, v11
    v_lshl_add_u32 v8, v0, 2, v6
    v_mul_f32 v24, v24, v11
    s_mov_b64 exec, 0xff
    ds_write_b32 v8, v24 offset:6144
    s_waitcnt lgkmcnt(0)
    s_mov_b64 exec, 1
    v_mov_b32 v7, 1
    ds_add_u32 v6, v7 offset:32
    s_mov_b64 exec, -1
    v_lshl_add_u32 v10, v3, 15, v2
    s_lshl_b32 s64, s52, 18
    s_and_b32 s61, s56, 31
    s_lshl_b32 s61, s61, 7
    s_add_u32 s64, s64, s61
    s_add_u32 s64, s64, 262144
    s_add_u32 s20, s64, 4096
    s_add_u32 s21, s64, 8192
    s_add_u32 s22, s64, 12288
    s_add_u32 s23, s64, 16384
    s_add_u32 s24, s64, 20480
    s_add_u32 s25, s64, 24576
    s_add_u32 s26, s64, 28672
    v_lshrrev_b32 v13, 1, v2
    v_lshl_add_u32 v13, v5, 1, v13
    v_add_u32 v13, v13, v6
    v_mov_b32 v12, 1
    v_mov_b32 v8, 0
    s_setprio 3
    s_mov_b32 s36, 192512
    s_mov_b32 s62, 1048576
L_spin_hint:
    ds_read_b32 v7, v6 offset:256
    s_waitcnt lgkmcnt(0)
    v_readfirstlane_b32 s61, v7
    s_cmp_ge_i32 s61, 144
    s_cbranch_scc1 L_spin_hint_done
    s_sleep 2
    s_sub_u32 s62, s62, 1
    s_cmp_lg_u32 s62, 0
    s_cbranch_scc1 L_spin_hint
L_spin_hint_done:
    s_mov_b64 exec, 1
    s_mov_b32 s62, 1048576
    buffer_load_dwordx2 v[40:41], v8, s[16:19], s36 offen sc1
    s_sleep 2
    buffer_load_dwordx2 v[42:43], v8, s[16:19], s36 offen sc1
    s_sleep 2
    buffer_load_dwordx2 v[44:45], v8, s[16:19], s36 offen sc1
    s_sleep 2
    buffer_load_dwordx2 v[46:47], v8, s[16:19], s36 offen sc1
    s_sleep 2
    buffer_load_dwordx2 v[48:49], v8, s[16:19], s36 offen sc1
    s_sleep 2
    buffer_load_dwordx2 v[50:51], v8, s[16:19], s36 offen sc1
    s_sleep 2
    buffer_load_dwordx2 v[52:53], v8, s[16:19], s36 offen sc1
    s_sleep 2
L_poll_go:
    buffer_load_dwordx2 v[54:55], v8, s[16:19], s36 offen sc1
    s_waitcnt vmcnt(7)
    v_cmp_ne_u64 vcc, s[6:7], v[40:41]
    s_cbranch_vccz L_poll_go_done
    s_sleep 2
    buffer_load_dwordx2 v[40:41], v8, s[16:19], s36 offen sc1
    s_waitcnt vmcnt(7)
    v_cmp_ne_u64 vcc, s[6:7], v[42:43]
    s_cbranch_vccz L_poll_go_done
    s_sleep 2
    buffer_load_dwordx2 v[42:43], v8, s[16:19], s36 offen sc1
    s_waitcnt vmcnt(7)
    v_cmp_ne_u64 vcc, s[6:7], v[44:45]
    s_cbranch_vccz L_poll_go_done
    s_sleep 2
    buffer_load_dwordx2 v[44:45], v8, s[16:19], s36 offen sc1
    s_waitcnt vmcnt(7)
    v_cmp_ne_u64 vcc, s[6:7], v[46:47]
    s_cbranch_vccz L_poll_go_done
    s_sleep 2
    buffer_load_dwordx2 v[46:47], v8, s[16:19], s36 offen sc1
    s_waitcnt vmcnt(7)
    v_cmp_ne_u64 vcc, s[6:7], v[48:49]
    s_cbranch_vccz L_poll_go_done
    s_sleep 2
    buffer_load_dwordx2 v[48:49], v8, s[16:19], s36 offen sc1
    s_waitcnt vmcnt(7)
    v_cmp_ne_u64 vcc, s[6:7], v[50:51]
    s_cbranch_vccz L_poll_go_done
    s_sleep 2
    buffer_load_dwordx2 v[50:51], v8, s[16:19], s36 offen sc1
    s_waitcnt vmcnt(7)
    v_cmp_ne_u64 vcc, s[6:7], v[52:53]
    s_cbranch_vccz L_poll_go_done
    s_sleep 2
    buffer_load_dwordx2 v[52:53], v8, s[16:19], s36 offen sc1
    s_waitcnt vmcnt(7)
    v_cmp_ne_u64 vcc, s[6:7], v[54:55]
    s_cbranch_vccz L_poll_go_done
    s_sleep 2
    s_sub_u32 s62, s62, 1
    s_cmp_lg_u32 s62, 0
    s_cbranch_scc1 L_poll_go
L_poll_go_done:
    s_mov_b64 exec, -1
    s_mov_b32 s62, 1048576
L_hop1:
    buffer_load_dwordx4 v[136:139], v10, s[16:19], s64 offen sc1
    buffer_load_dwordx4 v[140:143], v10, s[16:19], s20 offen sc1
    buffer_load_dwordx4 v[144:147], v10, s[16:19], s21 offen sc1
    buffer_load_dwordx4 v[148:151], v10, s[16:19], s22 offen sc1
    buffer_load_dwordx4 v[152:155], v10, s[16:19], s23 offen sc1
    buffer_load_dwordx4 v[156:159], v10, s[16:19], s24 offen sc1
    buffer_load_dwordx4 v[160:163], v10, s[16:19], s25 offen sc1
    buffer_load_dwordx4 v[164:167], v10, s[16:19], s26 offen sc1
    ds_write_b32 v6, v12 offset:16
    s_waitcnt vmcnt(4)
    v_xor_b32 v136, s32, v136
    v_xor_b32 v137, s33, v137
    v_xor_b32 v138, s34, v138
    v_xor_b32 v139, s35, v139
    v_xor_b32 v140, s32, v140
    v_xor_b32 v141, s33, v141
    v_xor_b32 v142, s34, v142
    v_xor_b32 v143, s35, v143
    v_xor_b32 v144, s32, v144
    v_xor_b32 v145, s33, v145
    v_xor_b32 v146, s34, v146
    v_xor_b32 v147, s35, v147
    v_xor_b32 v148, s32, v148
    v_xor_b32 v149, s33, v149
    v_xor_b32 v150, s34, v150
    v_xor_b32 v151, s35, v151
    v_or_b32 v1, v136, v137
    v_or3_b32 v1, v1, v138, v139
    v_or3_b32 v1, v1, v140, v141
    v_or3_b32 v1, v1, v142, v143
    v_or3_b32 v1, v1, v144, v145
    v_or3_b32 v1, v1, v146, v147
    v_or3_b32 v1, v1, v148, v149
    v_or3_b32 v1, v1, v150, v151
    v_pk_add_f32 v[136:137], v[136:137], v[140:141]
    v_pk_add_f32 v[144:145], v[144:145], v[148:149]
    v_pk_add_f32 v[138:139], v[138:139], v[142:143]
    v_pk_add_f32 v[146:147], v[146:147], v[150:151]
    v_pk_add_f32 v[136:137], v[136:137], v[144:145]
    v_pk_add_f32 v[138:139], v[138:139], v[146:147]
    s_waitcnt vmcnt(0)
    v_xor_b32 v152, s32, v152
    v_xor_b32 v153, s33, v153
    v_xor_b32 v154, s34, v154
    v_xor_b32 v155, s35, v155
    v_xor_b32 v156, s32, v156
    v_xor_b32 v157, s33, v157
    v_xor_b32 v158, s34, v158
    v_xor_b32 v159, s35, v159
    v_xor_b32 v160, s32, v160
    v_xor_b32 v161, s33, v161
    v_xor_b32 v162, s34, v162
    v_xor_b32 v163, s35, v163
    v_xor_b32 v164, s32, v164
    v_xor_b32 v165, s33, v165
    v_xor_b32 v166, s34, v166
    v_xor_b32 v167, s35, v167
    v_or3_b32 v1, v1, v152, v153
    v_or3_b32 v1, v1, v154, v155
    v_or3_b32 v1, v1, v156, v157
    v_or3_b32 v1, v1, v158, v159
    v_or3_b32 v1, v1, v160, v161
    v_or3_b32 v1, v1, v162, v163
    v_or3_b32 v1, v1, v164, v165
    v_or3_b32 v1, v1, v166, v167
    v_and_b32 v1, 0xff, v1
    v_cmp_ne_u32 vcc, 0, v1
    s_cbranch_vccz L_hop1_done
    s_sub_u32 s62, s62, 1
    s_cmp_lg_u32 s62, 0
    s_cbranch_scc1 L_hop1
L_hop1_done:
    v_pk_add_f32 v[152:153], v[152:153], v[156:157]
    v_pk_add_f32 v[160:161], v[160:161], v[164:165]
    v_pk_add_f32 v[154:155], v[154:155], v[158:159]
    v_pk_add_f32 v[162:163], v[162:163], v[166:167]
    v_pk_add_f32 v[152:153], v[152:153], v[160:161]
    v_pk_add_f32 v[154:155], v[154:155], v[162:163]
    v_add_f32 v136, v136, v152
    v_add_f32 v137, v137, v153
    v_add_f32 v138, v138, v154
    v_add_f32 v139, v139, v155
    s_nop 1
    v_permlane16_swap_b32 v136, v137
    v_permlane16_swap_b32 v138, v139
    v_add_f32 v136, v136, v137
    v_add_f32 v138, v138, v139
    s_nop 1
    v_permlane32_swap_b32 v136, v138
    v_add_f32 v136, v136, v138
    s_nop 1
    v_add_f32_dpp v136, v136, v136 row_ror:8 row_mask:0xf bank_mask:0xf
    v_cvt_pk_bf16_f32 v136, v136, v136
    ds_write_b16 v13, v136 offset:128
    s_mov_b64 exec, 1
    ds_write_b32 v6, v12 offset:28
    s_endpgm
L_a2:
    s_mov_b32 s53, s54
    s_cmp_lt_u32 s2, 224
    s_cselect_b32 s51, 1, 0
    v_and_b32 v8, 15, v0
    v_lshlrev_b32 v8, 4, v8
    v_mul_u32_u24 v10, 57344, v5
    v_add_u32 v10, v10, v8
    v_lshl_add_u32 v11, v5, 10, v8
    v_add_u32 v11, v11, v6
    s_add_u32 s60, s53, 1
    s_cmp_ge_u32 s60, 56
    s_cselect_b32 s29, 56, 0
    s_sub_u32 s60, s60, s29
    s_add_u32 s61, s53, 2
    s_cmp_ge_u32 s61, 56
    s_cselect_b32 s29, 56, 0
    s_sub_u32 s61, s61, s29
    s_lshl_b32 s60, s60, 8
    s_lshl_b32 s61, s61, 8
    v_mov_b32 v9, s60
    v_mov_b32 v1, s61
    v_cmp_eq_u32 vcc, 1, v5
    s_mul_i32 s63, s55, 14336
    s_add_u32 s63, s63, 65536
    v_cndmask_b32 v9, v9, v1, vcc
    v_add_u32 v10, v10, v9
    s_cmp_eq_u32 s51, 0
    s_cbranch_scc1 L_a2_h
    s_mov_b32 s62, 1048576
L_spin_gu:
    ds_read_b32 v7, v6 offset:20
    s_waitcnt lgkmcnt(0)
    v_readfirstlane_b32 s61, v7
    s_cmp_ge_i32 s61, 8
    s_cbranch_scc1 L_spin_gu_done
    s_sleep 4
    s_sub_u32 s62, s62, 1
    s_cmp_lg_u32 s62, 0
    s_cbranch_scc1 L_spin_gu
L_spin_gu_done:
    s_mov_b32 exec_hi, 0
    ds_read_b128 v[40:43], v11 offset:1536
    ds_read_b128 v[44:47], v11 offset:1792
    ds_read_b128 v[48:51], v11 offset:2048
    ds_read_b128 v[52:55], v11 offset:2304
    s_waitcnt lgkmcnt(0)
    v_pk_add_f32 v[40:41], v[40:41], v[44:45]
    v_pk_add_f32 v[48:49], v[48:49], v[52:53]
    v_pk_add_f32 v[42:43], v[42:43], v[46:47]
    v_pk_add_f32 v[50:51], v[50:51], v[54:55]
    v_pk_add_f32 v[40:41], v[40:41], v[48:49]
    v_pk_add_f32 v[42:43], v[42:43], v[50:51]
    v_bfi_b32 v40, v4, s32, v40
    v_bfi_b32 v41, v4, s33, v41
    v_bfi_b32 v42, v4, s34, v42
    v_bfi_b32 v43, v4, s35, v43
    buffer_store_dwordx4 v[40:43], v10, s[16:19], s63 offen sc1
    s_mov_b64 exec, -1
L_a2_h:
    v_mul_u32_u24 v8, 14336, v3
    v_add_u32 v8, v8, v2
    s_mul_i32 s60, s56, 112
    s_add_u32 s60, s60, 65536
    s_mov_b32 s62, 1048576
L_spin_th:
    ds_read_b32 v7, v6 offset:256
    s_waitcnt lgkmcnt(0)
    v_readfirstlane_b32 s61, v7
    s_cmp_ge_i32 s61, 112
    s_cbranch_scc1 L_spin_th_done
    s_sleep 8
    s_sub_u32 s62, s62, 1
    s_cmp_lg_u32 s62, 0
    s_cbranch_scc1 L_spin_th
L_spin_th_done:
    s_mov_b32 exec_lo, 0x7f7f7f7f
    s_mov_b32 exec_hi, 0x7f7f7f7f
    s_mov_b32 s62, 1048576
L_poll_h:
    buffer_load_dwordx4 v[136:139], v8, s[16:19], s60 offen sc1
    s_waitcnt vmcnt(0)
    v_xor_b32 v136, s32, v136
    v_xor_b32 v137, s33, v137
    v_xor_b32 v138, s34, v138
    v_xor_b32 v139, s35, v139
    v_or_b32 v9, v136, v137
    v_or3_b32 v9, v9, v138, v139
    v_and_b32 v9, 0xff, v9
    v_cmp_ne_u32 vcc, 0, v9
    s_cbranch_vccz L_poll_h_done
    s_sub_u32 s62, s62, 1
    s_cmp_lg_u32 s62, 0
    s_cbranch_scc1 L_poll_h
L_poll_h_done:
    s_mov_b64 exec, -1
    s_nop 1
    v_add_f32_dpp v136, v136, v136 row_ror:8 row_mask:0xf bank_mask:0xf
    v_add_f32_dpp v137, v137, v137 row_ror:8 row_mask:0xf bank_mask:0xf
    v_add_f32_dpp v138, v138, v138 row_ror:8 row_mask:0xf bank_mask:0xf
    v_add_f32_dpp v139, v139, v139 row_ror:8 row_mask:0xf bank_mask:0xf
    v_mov_b32 v140, v136
    v_mov_b32 v141, v137
    v_mov_b32 v142, v138
    v_mov_b32 v143, v139
    s_nop 1
    v_permlane16_swap_b32 v136, v140
    v_permlane16_swap_b32 v137, v141
    v_permlane16_swap_b32 v138, v142
    v_permlane16_swap_b32 v139, v143
    v_add_f32 v136, v136, v140
    v_add_f32 v137, v137, v141
    v_add_f32 v138, v138, v142
    v_add_f32 v139, v139, v143
    v_mov_b32 v140, v136
    v_mov_b32 v141, v137
    v_mov_b32 v142, v138
    v_mov_b32 v143, v139
    s_nop 1
    v_permlane32_swap_b32 v136, v140
    v_permlane32_swap_b32 v137, v141
    v_permlane32_swap_b32 v138, v142
    v_permlane32_swap_b32 v139, v143
    v_cvt_pk_bf16_f32 v144, v136, v140
    v_cvt_pk_bf16_f32 v145, v137, v141
    v_cvt_pk_bf16_f32 v146, v138, v142
    v_cvt_pk_bf16_f32 v147, v139, v143
    v_lshlrev_b32 v136, 16, v144
    v_and_b32 v140, 0xffff0000, v144
    v_max_f32 v136, 0, v136
    v_mul_f32 v136, v136, v140
    v_cvt_pk_bf16_f32 v136, v136, v136
    v_lshlrev_b32 v137, 16, v145
    v_and_b32 v141, 0xffff0000, v145
    v_max_f32 v137, 0, v137
    v_mul_f32 v137, v137, v141
    v_cvt_pk_bf16_f32 v137, v137, v137
    v_lshlrev_b32 v138, 16, v146
    v_and_b32 v142, 0xffff0000, v146
    v_max_f32 v138, 0, v138
    v_mul_f32 v138, v138, v142
    v_cvt_pk_bf16_f32 v138, v138, v138
    v_lshlrev_b32 v139, 16, v147
    v_and_b32 v143, 0xffff0000, v147
    v_max_f32 v139, 0, v139
    v_mul_f32 v139, v139, v143
    v_cvt_pk_bf16_f32 v139, v139, v139
    s_mov_b64 exec, 0x7f
    v_lshl_add_u32 v8, v0, 2, 0
    v_mul_u32_u24 v9, 37, v8
    v_lshrrev_b32 v9, 8, v9
    v_add_lshl_u32 v8, v8, v9, 1
    v_add_u32 v8, v8, v6
    ds_write_b16 v8, v136 offset:192
    v_lshl_add_u32 v8, v0, 2, 1
    v_mul_u32_u24 v9, 37, v8
    v_lshrrev_b32 v9, 8, v9
    v_add_lshl_u32 v8, v8, v9, 1
    v_add_u32 v8, v8, v6
    ds_write_b16 v8, v137 offset:192
    v_lshl_add_u32 v8, v0, 2, 2
    v_mul_u32_u24 v9, 37, v8
    v_lshrrev_b32 v9, 8, v9
    v_add_lshl_u32 v8, v8, v9, 1
    v_add_u32 v8, v8, v6
    ds_write_b16 v8, v138 offset:192
    v_lshl_add_u32 v8, v0, 2, 3
    v_mul_u32_u24 v9, 37, v8
    v_lshrrev_b32 v9, 8, v9
    v_add_lshl_u32 v8, v8, v9, 1
    v_add_u32 v8, v8, v6
    ds_write_b16 v8, v139 offset:192
    s_mov_b64 exec, -1
    s_mov_b32 s62, 1048576
L_spin_fg:
    ds_read_b32 v7, v6 offset:36
    s_waitcnt lgkmcnt(0)
    v_readfirstlane_b32 s61, v7
    s_cmp_ge_i32 s61, 1
    s_cbranch_scc1 L_spin_fg_done
    s_sleep 2
    s_sub_u32 s62, s62, 1
    s_cmp_lg_u32 s62, 0
    s_cbranch_scc1 L_spin_fg
L_spin_fg_done:
    s_mov_b64 exec, 1
    v_mov_b32 v7, 1
    ds_add_u32 v6, v7 offset:24
    s_mov_b64 exec, -1
    s_cmp_ge_u32 s2, 128
    s_cbranch_scc1 L_a2_end
    s_lshr_b32 s66, s2, 5
    s_lshl_b32 s66, s66, 3
    s_and_b32 s61, s2, 7
    s_add_u32 s66, s66, s61
    s_lshl_b32 s66, s66, 2
    s_lshr_b32 s61, s2, 3
    s_and_b32 s61, s61, 3
    s_add_u32 s66, s66, s61
    s_lshr_b32 s61, s66, 6
    s_lshl_b32 s67, s61, 11
    s_and_b32 s61, s66, 63
    s_lshl_b32 s61, s61, 5
    s_add_u32 s67, s67, s61
    s_add_u32 s67, s67, 1310720
    s_add_u32 s20, s67, 131072
    s_add_u32 s21, s67, 262144
    s_add_u32 s22, s67, 393216
    s_lshl_b32 s66, s66, 4
    v_lshrrev_b32 v14, 1, v0
    v_lshlrev_b32 v14, 12, v14
    v_and_b32 v15, 1, v0
    v_lshl_add_u32 v14, v15, 4, v14
    v_lshlrev_b32 v15, 3, v15
    v_lshl_add_u32 v15, v5, 1, v15
    s_mov_b32 s24, s44
    s_mov_b32 s25, s45
    s_movk_i32 s26, 2048
    s_mov_b32 s27, 0x20000
    s_mov_b32 s62, 1048576
L_spin_late2:
    ds_read_b32 v7, v6 offset:256
    s_waitcnt lgkmcnt(0)
    v_readfirstlane_b32 s61, v7
    s_cmp_ge_i32 s61, 144
    s_cbranch_scc1 L_spin_late2_done
    s_sleep 8
    s_sub_u32 s62, s62, 1
    s_cmp_lg_u32 s62, 0
    s_cbranch_scc1 L_spin_late2
L_spin_late2_done:
    s_mov_b32 s62, 1048576
L_spin_go2:
    ds_read_b32 v7, v6 offset:16
    s_waitcnt lgkmcnt(0)
    v_readfirstlane_b32 s61, v7
    s_cmp_ge_i32 s61, 1
    s_cbranch_scc1 L_spin_go2_done
    s_sub_u32 s62, s62, 1
    s_cmp_lg_u32 s62, 0
    s_cbranch_scc1 L_spin_go2
L_spin_go2_done:
    s_sleep 28
    s_mov_b32 s62, 1048576
L_spin_fob2:
    ds_read_b32 v7, v6 offset:28
    s_waitcnt lgkmcnt(0)
    v_readfirstlane_b32 s61, v7
    s_cmp_ge_i32 s61, 1
    s_cbranch_scc1 L_spin_fob2_done
    s_sub_u32 s62, s62, 1
    s_cmp_lg_u32 s62, 0
    s_cbranch_scc1 L_spin_fob2
L_spin_fob2_done:
    s_sleep 9
    s_setprio 3
    s_mov_b32 s62, 1048576
L_hop2:
    buffer_load_dwordx4 v[136:139], v14, s[16:19], s67 offen sc1
    buffer_load_dwordx4 v[140:143], v14, s[16:19], s20 offen sc1
    buffer_load_dwordx4 v[144:147], v14, s[16:19], s21 offen sc1
    buffer_load_dwordx4 v[148:151], v14, s[16:19], s22 offen sc1
    s_waitcnt vmcnt(0)
    v_xor_b32 v136, s32, v136
    v_xor_b32 v137, s33, v137
    v_xor_b32 v138, s34, v138
    v_xor_b32 v139, s35, v139
    v_xor_b32 v140, s32, v140
    v_xor_b32 v141, s33, v141
    v_xor_b32 v142, s34, v142
    v_xor_b32 v143, s35, v143
    v_xor_b32 v144, s32, v144
    v_xor_b32 v145, s33, v145
    v_xor_b32 v146, s34, v146
    v_xor_b32 v147, s35, v147
    v_xor_b32 v148, s32, v148
    v_xor_b32 v149, s33, v149
    v_xor_b32 v150, s34, v150
    v_xor_b32 v151, s35, v151
    v_or_b32 v1, v136, v137
    v_or3_b32 v1, v1, v138, v139
    v_or3_b32 v1, v1, v140, v141
    v_or3_b32 v1, v1, v142, v143
    v_or3_b32 v1, v1, v144, v145
    v_or3_b32 v1, v1, v146, v147
    v_or3_b32 v1, v1, v148, v149
    v_or3_b32 v1, v1, v150, v151
    v_and_b32 v1, 0xff, v1
    v_cmp_ne_u32 vcc, 0, v1
    s_cbranch_vccz L_hop2_done
    s_sub_u32 s62, s62, 1
    s_cmp_lg_u32 s62, 0
    s_cbranch_scc1 L_hop2
L_hop2_done:
    v_pk_add_f32 v[136:137], v[136:137], v[140:141]
    v_pk_add_f32 v[144:145], v[144:145], v[148:149]
    v_pk_add_f32 v[138:139], v[138:139], v[142:143]
    v_pk_add_f32 v[146:147], v[146:147], v[150:151]
    v_pk_add_f32 v[136:137], v[136:137], v[144:145]
    v_pk_add_f32 v[138:139], v[138:139], v[146:147]
    s_nop 1
    v_permlane16_swap_b32 v136, v137
    v_permlane16_swap_b32 v138, v139
    v_add_f32 v136, v136, v137
    v_add_f32 v138, v138, v139
    s_nop 1
    v_permlane32_swap_b32 v136, v138
    v_add_f32 v136, v136, v138
    s_nop 1
    v_add_f32_dpp v136, v136, v136 row_ror:8 row_mask:0xf bank_mask:0xf
    s_nop 1
    v_add_f32_dpp v136, v136, v136 row_ror:4 row_mask:0xf bank_mask:0xf
    s_nop 1
    v_add_f32_dpp v136, v136, v136 row_ror:2 row_mask:0xf bank_mask:0xf
    v_cvt_pk_bf16_f32 v136, v136, v136
    s_mov_b32 exec_lo, 0x00030003
    s_mov_b32 exec_hi, 0x00030003
    buffer_store_short v136, v15, s[24:27], s66 offen sc1
    s_cmp_lg_u32 s2, 0
    s_cbranch_scc1 L_a2_end
    s_mov_b64 exec, 1
    v_mov_b32 v8, 0
    v_mov_b32 v9, s6
    buffer_store_dword v9, v8, s[16:19], 0 offen sc1
L_a2_end:
    s_endpgm
L_a3:
    s_mov_b32 s24, s42
    s_mov_b32 s25, s43
    s_movk_i32 s26, 2048
    s_mov_b32 s27, 0x20000
    v_lshlrev_b32 v9, 5, v0
    buffer_load_dwordx4 v[136:139], v9, s[12:15], 0 offen
    buffer_load_dwordx4 v[140:143], v9, s[12:15], 0 offen offset:16
    buffer_load_dwordx4 v[144:147], v9, s[24:27], 0 offen
    buffer_load_dwordx4 v[148:151], v9, s[24:27], 0 offen offset:16
    s_movk_i32 s20, 1000
    s_mov_b32 s21, 0
    s_mov_b32 s58, 0
    v_mov_b32 v4, 0
    v_mov_b32 v5, 0
    v_mov_b32 v16, 0
    v_mov_b32 v18, 0
    s_branch L_phases
L_a3_cont:
    v_mov_b32 v8, 0
    s_waitcnt vmcnt(0)
    v_lshlrev_b32 v9, 16, v136
    v_lshlrev_b32 v10, 16, v144
    v_and_b32 v11, 0xffff0000, v136
    v_and_b32 v7, 0xffff0000, v144
    v_mul_f32 v9, v9, v10
    v_mul_f32 v11, v11, v7
    v_cvt_pk_bf16_f32 v9, v9, v11
    v_lshlrev_b32 v10, 16, v9
    v_and_b32 v11, 0xffff0000, v9
    v_add_f32 v8, v8, v10
    v_add_f32 v8, v8, v11
    v_lshlrev_b32 v9, 16, v137
    v_lshlrev_b32 v10, 16, v145
    v_and_b32 v11, 0xffff0000, v137
    v_and_b32 v7, 0xffff0000, v145
    v_mul_f32 v9, v9, v10
    v_mul_f32 v11, v11, v7
    v_cvt_pk_bf16_f32 v9, v9, v11
    v_lshlrev_b32 v10, 16, v9
    v_and_b32 v11, 0xffff0000, v9
    v_add_f32 v8, v8, v10
    v_add_f32 v8, v8, v11
    v_lshlrev_b32 v9, 16, v138
    v_lshlrev_b32 v10, 16, v146
    v_and_b32 v11, 0xffff0000, v138
    v_and_b32 v7, 0xffff0000, v146
    v_mul_f32 v9, v9, v10
    v_mul_f32 v11, v11, v7
    v_cvt_pk_bf16_f32 v9, v9, v11
    v_lshlrev_b32 v10, 16, v9
    v_and_b32 v11, 0xffff0000, v9
    v_add_f32 v8, v8, v10
    v_add_f32 v8, v8, v11
    v_lshlrev_b32 v9, 16, v139
    v_lshlrev_b32 v10, 16, v147
    v_and_b32 v11, 0xffff0000, v139
    v_and_b32 v7, 0xffff0000, v147
    v_mul_f32 v9, v9, v10
    v_mul_f32 v11, v11, v7
    v_cvt_pk_bf16_f32 v9, v9, v11
    v_lshlrev_b32 v10, 16, v9
    v_and_b32 v11, 0xffff0000, v9
    v_add_f32 v8, v8, v10
    v_add_f32 v8, v8, v11
    v_lshlrev_b32 v9, 16, v140
    v_lshlrev_b32 v10, 16, v148
    v_and_b32 v11, 0xffff0000, v140
    v_and_b32 v7, 0xffff0000, v148
    v_mul_f32 v9, v9, v10
    v_mul_f32 v11, v11, v7
    v_cvt_pk_bf16_f32 v9, v9, v11
    v_lshlrev_b32 v10, 16, v9
    v_and_b32 v11, 0xffff0000, v9
    v_add_f32 v8, v8, v10
    v_add_f32 v8, v8, v11
    v_lshlrev_b32 v9, 16, v141
    v_lshlrev_b32 v10, 16, v149
    v_and_b32 v11, 0xffff0000, v141
    v_and_b32 v7, 0xffff0000, v149
    v_mul_f32 v9, v9, v10
    v_mul_f32 v11, v11, v7
    v_cvt_pk_bf16_f32 v9, v9, v11
    v_lshlrev_b32 v10, 16, v9
    v_and_b32 v11, 0xffff0000, v9
    v_add_f32 v8, v8, v10
    v_add_f32 v8, v8, v11
    v_lshlrev_b32 v9, 16, v142
    v_lshlrev_b32 v10, 16, v150
    v_and_b32 v11, 0xffff0000, v142
    v_and_b32 v7, 0xffff0000, v150
    v_mul_f32 v9, v9, v10
    v_mul_f32 v11, v11, v7
    v_cvt_pk_bf16_f32 v9, v9, v11
    v_lshlrev_b32 v10, 16, v9
    v_and_b32 v11, 0xffff0000, v9
    v_add_f32 v8, v8, v10
    v_add_f32 v8, v8, v11
    v_lshlrev_b32 v9, 16, v143
    v_lshlrev_b32 v10, 16, v151
    v_and_b32 v11, 0xffff0000, v143
    v_and_b32 v7, 0xffff0000, v151
    v_mul_f32 v9, v9, v10
    v_mul_f32 v11, v11, v7
    v_cvt_pk_bf16_f32 v9, v9, v11
    v_lshlrev_b32 v10, 16, v9
    v_and_b32 v11, 0xffff0000, v9
    v_add_f32 v8, v8, v10
    v_add_f32 v8, v8, v11
    s_nop 1
    v_add_f32_dpp v8, v8, v8 row_ror:1 row_mask:0xf bank_mask:0xf
    s_nop 1
    v_add_f32_dpp v8, v8, v8 row_ror:2 row_mask:0xf bank_mask:0xf
    s_nop 1
    v_add_f32_dpp v8, v8, v8 row_ror:4 row_mask:0xf bank_mask:0xf
    s_nop 1
    v_add_f32_dpp v8, v8, v8 row_ror:8 row_mask:0xf bank_mask:0xf
    v_mov_b32 v7, v8
    s_nop 1
    v_permlane16_swap_b32 v8, v7
    v_add_f32 v8, v8, v7
    v_mov_b32 v7, v8
    s_nop 1
    v_permlane32_swap_b32 v8, v7
    v_add_f32 v8, v8, v7
    v_cvt_pk_bf16_f32 v8, v8, v8
    v_and_b32 v8, 0xffff0000, v8
    v_mul_f32 v8, 0xbfb8aa3b, v8
    v_exp_f32 v8, v8
    s_nop 0
    v_add_f32 v8, 1.0, v8
    v_rcp_f32 v8, v8
    s_nop 0
    v_cvt_pk_bf16_f32 v8, v8, v8
    v_and_b32 v8, 0xffff0000, v8
    v_sub_f32 v9, 1.0, v8
    v_cvt_pk_bf16_f32 v9, v9, v9
    v_and_b32 v9, 0xffff0000, v9
    s_mov_b64 exec, 1
    ds_write_b64 v6, v[8:9] offset:40
    s_waitcnt lgkmcnt(0)
    s_mov_b64 exec, 1
    v_mov_b32 v7, 1
    ds_add_u32 v6, v7 offset:36
    s_mov_b64 exec, -1
    s_add_u32 s6, s6, 0x9e3779b9
    s_not_b32 s7, s6
    v_lshlrev_b32 v8, 7, v0
    v_mov_b32 v16, s6
    v_mov_b32 v17, s7
    s_mov_b32 s36, 229376
    s_mov_b32 s37, 237568
    s_mov_b32 s38, 245760
    s_mov_b32 s39, 253952
    s_mul_i32 s60, s2, 4
    s_add_u32 s60, s60, 229376
    s_mov_b32 s62, 1048576
L_spin_watch0:
    ds_read_b32 v7, v6 offset:256
    s_waitcnt lgkmcnt(0)
    v_readfirstlane_b32 s61, v7
    s_cmp_ge_i32 s61, 136
    s_cbranch_scc1 L_spin_watch0_done
    s_sleep 8
    s_sub_u32 s62, s62, 1
    s_cmp_lg_u32 s62, 0
    s_cbranch_scc1 L_spin_watch0
L_spin_watch0_done:
    s_mov_b32 s62, 1048576
L_spin_watch:
    ds_read_b32 v7, v6 offset:256
    s_waitcnt lgkmcnt(0)
    v_readfirstlane_b32 s61, v7
    s_cmp_ge_i32 s61, 144
    s_cbranch_scc1 L_spin_watch_done
    s_sub_u32 s62, s62, 1
    s_cmp_lg_u32 s62, 0
    s_cbranch_scc1 L_spin_watch
L_spin_watch_done:
    s_mov_b64 exec, 1
    buffer_store_dword v16, v8, s[16:19], s60 offen sc1
    s_cmp_lg_u32 s2, 255
    s_cbranch_scc1 L_a3_end
    s_mov_b64 exec, -1
    s_mov_b32 s60, 192512
    s_mov_b32 s62, 1048576
    v_mul_u32_u24 v9, 16, v0
L_watch:
    buffer_load_dwordx4 v[40:43], v9, s[16:19], s36 offen sc1
    s_waitcnt vmcnt(0)
    v_xor_b32 v40, s6, v40
    v_xor_b32 v41, s6, v41
    v_xor_b32 v42, s6, v42
    v_xor_b32 v43, s6, v43
    v_or3_b32 v40, v40, v41, v42
    v_or_b32 v40, v40, v43
    v_cmp_ne_u32 vcc, 0, v40
    s_cbranch_vccz L_watch_done
    s_sub_u32 s62, s62, 1
    s_cmp_lg_u32 s62, 0
    s_cbranch_scc1 L_watch
L_watch_done:
    s_mov_b64 exec, 1
    buffer_store_dwordx2 v[16:17], v8, s[16:19], s60 offen sc1
L_a3_end:
    s_endpgm
L_end:
    s_endpgm
L_code_end:
.section .rodata,"a"
.p2align 6
.amdhsa_kernel gated_mix__gqa_block_cached__glu_gated_reglu__decode_kernel
  .amdhsa_next_free_vgpr 168
  .amdhsa_next_free_sgpr 80
  .amdhsa_accum_offset 168
  .amdhsa_group_segment_fixed_size 0
  .amdhsa_kernarg_size 104
  .amdhsa_user_sgpr_count 2
  .amdhsa_user_sgpr_kernarg_segment_ptr 1
  .amdhsa_system_sgpr_workgroup_id_x 1
.end_amdhsa_kernel
```
